```python
import torch

def _softmax(x, axis=-1):
    return torch.softmax(x, dim=axis)
def _gelu(x):
    return torch.nn.functional.gelu(x, approximate="tanh")
def _silu(x):
    return torch.nn.functional.silu(x)
def _sigmoid(x):
    return torch.sigmoid(x)
def _layernorm(x, axis=-1, eps=1e-5):
    m = x.mean(dim=axis, keepdim=True)
    v = x.var(dim=axis, keepdim=True, unbiased=False)
    return (x - m) / torch.sqrt(v + eps)
def _scatter_add(tgt, idx, src, axis=0):
    return tgt.clone().index_add_(axis, idx, src)
def _segment_sum(src, seg, n):
    out = torch.zeros((n,) + src.shape[1:], dtype=src.dtype)
    return out.index_add_(0, seg, src)
def _pad(x, pw):
    flat = tuple(v for pair in reversed(pw) for v in pair)
    return torch.nn.functional.pad(x, flat)

kernel_name = 'recurrent_scan__linear_kernel_hedgehog__mixer_channel_mlp__prompt'

def setup_inputs():

    _w = (lambda a: (lambda t: t.to(torch.bfloat16) if t.is_floating_point() else t)(torch.as_tensor(a)))
    def _A_setup():
        B, S, D, H = 1, 2048, 512, 32
        Dh = D // H
        return {
            "x": _w((lambda *s: torch.randn(*s, dtype=torch.bfloat16) * 0.05)(B, S, D)),
            "wqkv": _w((lambda *s: torch.randn(*s, dtype=torch.bfloat16) * 0.2)(D, 3 * D)),
            "w_phi": _w((lambda *s: torch.randn(*s, dtype=torch.bfloat16) * 0.2)(H, Dh, Dh) * (Dh ** -0.5)),
            "wo": _w((lambda *s: torch.randn(*s, dtype=torch.bfloat16) * 0.2)(D, D)),
        }
    _A_in = _A_setup()

    def _B_setup():
        B, S, D, F = 1, 2048, 512, 1376
        return {
            "x": _w((lambda *s: torch.randn(*s, dtype=torch.bfloat16) * 0.05)(B, S, D)),
            "w1": _w((lambda *s: torch.randn(*s, dtype=torch.bfloat16) * 0.8)(D, F) * (D ** -0.5)),
            "b1": _w((lambda *s: torch.randn(*s, dtype=torch.bfloat16) * 0.8)(F)),
            "w2": _w((lambda *s: torch.randn(*s, dtype=torch.bfloat16) * 0.1)(F, D) * (F ** -0.5)),
            "b2": _w((lambda *s: torch.randn(*s, dtype=torch.bfloat16) * 0.1)(D)),
        }
    _B_in = _B_setup()

    return {
        "A_x": _A_in["x"],
        "A_wqkv": _A_in["wqkv"],
        "A_w_phi": _A_in["w_phi"],
        "A_wo": _A_in["wo"],
        "B_x": _B_in["x"],
        "B_w1": _B_in["w1"],
        "B_b1": _B_in["b1"],
        "B_w2": _B_in["w2"],
        "B_b2": _B_in["b2"],
    }

def reference(A_x, A_wqkv, A_w_phi, A_wo, B_x, B_w1, B_b1, B_w2, B_b2):
    def _A_ref(x, wqkv, w_phi, wo):
        B, S, D = x.shape
        H = 32; Dh = D // H
        qkv = (lambda x, *d: x.permute(*d))((x @ wqkv).reshape(B, S, 3, H, Dh), 2, 0, 3, 1, 4)
        q, k, v = qkv[0], qkv[1], qkv[2]
        pq = torch.einsum("bhsd,hdf->bhsf", q, w_phi)
        pk = torch.einsum("bhsd,hdf->bhsf", k, w_phi)
        phi_q = torch.concatenate([_softmax(pq, axis=-1), _softmax(-pq, axis=-1)], axis=-1)
        phi_k = torch.concatenate([_softmax(pk, axis=-1), _softmax(-pk, axis=-1)], axis=-1)
        kv = torch.einsum("bhsf,bhsd->bhfd", phi_k, v)
        z  = torch.einsum("bhsf->bhf", phi_k)
        num = torch.einsum("bhqf,bhfd->bhqd", phi_q, kv)
        den = torch.einsum("bhqf,bhf->bhq", phi_q, z)[..., None] + 1e-6
        o = num / den
        return (lambda x, *d: x.permute(*d))(o, 0, 2, 1, 3).reshape(B, S, D) @ wo

    def _B_ref(x, w1, b1, w2, b2):
        y = _layernorm(x, axis=-1)
        h = _gelu(torch.einsum("bsd,df->bsf", y, w1) + b1)
        return torch.einsum("bsf,fd->bsd", h, w2) + b2

    x = A_x
    xn = _layernorm(x, axis=-1)
    s = _A_ref(xn, A_wqkv, A_w_phi, A_wo)
    g = _silu(_B_ref(xn, B_w1, B_b1, B_w2, B_b2))
    return x + s * g
```

```asm
; @launch grid=(256,1,1) block=(512,1,1) lds=163840
.amdgcn_target "amdgcn-amd-amdhsa--gfx950"
.text
.globl recurrent_scan__linear_kernel_hedgehog__mixer_channel_mlp__prompt_kernel
.p2align 8
.type recurrent_scan__linear_kernel_hedgehog__mixer_channel_mlp__prompt_kernel,@function
recurrent_scan__linear_kernel_hedgehog__mixer_channel_mlp__prompt_kernel:
    s_cmp_ge_u32 s2, 256
    s_cbranch_scc1 L_end
    s_load_dwordx16 s[4:19], s[0:1], 0
    s_load_dwordx8 s[20:27], s[0:1], 64
    s_memrealtime s[98:99]
    v_lshrrev_b32 v2, 6, v0
    v_and_b32 v1, 63, v0
    v_readfirstlane_b32 s64, v2
    s_and_b32 s69, s2, 7
    s_lshr_b32 s72, s2, 3
    s_lshr_b32 s67, s72, 4
    s_and_b32 s68, s72, 15
    s_lshr_b32 s85, s72, 3
    s_lshl_b32 s73, s69, 2
    s_add_u32 s85, s85, s73
    s_and_b32 s86, s72, 7
    s_lshr_b32 s73, s69, 2
    s_lshl_b32 s73, s73, 3
    s_lshl_b32 s69, s69, 1
    s_and_b32 s69, s69, 7
    s_and_b32 s74, s68, 1
    s_or_b32 s69, s69, s74
    s_lshr_b32 s68, s68, 1
    s_or_b32 s68, s68, s73
    s_and_b32 s65, s64, 3
    s_lshr_b32 s66, s64, 2
    s_lshr_b32 s70, s69, 1
    s_add_u32 s70, s70, s68
    s_cmp_eq_u32 s67, 0
    s_mov_b32 s71, 2752
    s_cmov_b32 s71, 3072
    s_mov_b32 s73, 352
    s_cmov_b32 s73, 128
    s_mov_b32 s74, 128
    s_cmov_b32 s74, 1024
    s_mul_i32 s81, s69, s73
    s_add_u32 s82, s81, s74
    s_add_u32 s83, s82, s74
    s_lshl_b32 s84, s71, 6
    s_cmp_eq_u32 s69, 7
    s_cselect_b32 s75, 2, 6
    s_cmp_eq_u32 s67, 0
    s_cselect_b32 s75, 8, s75
    s_mov_b32 s90, 0x3f803f80
    s_lshl_b32 s76, s64, 11
    s_lshl_b32 s77, s64, 10
    v_lshrrev_b32 v2, 3, v1
    v_and_b32 v3, 7, v1
    v_lshrrev_b32 v4, 4, v1
    s_lshl_b32 s78, s68, 7
    s_lshl_b32 s79, s64, 4
    s_add_u32 s79, s78, s79
    v_add_u32 v5, s79, v2
    v_lshlrev_b32 v5, 10, v5
    v_xor_b32 v6, v3, v4
    v_lshl_add_u32 v138, v6, 4, v5
    v_xor_b32 v6, 4, v6
    v_lshl_add_u32 v139, v6, 4, v5
    v_add_u32 v139, 0x2000, v139
    s_lshl_b32 s79, s64, 3
    v_add_u32 v5, s79, v2
    v_mul_lo_u32 v5, v5, s71
    v_and_b32 v6, 1, v4
    v_lshlrev_b32 v6, 2, v6
    v_xor_b32 v6, v6, v3
    v_lshl_add_u32 v140, v6, 4, v5
    v_cmp_gt_u32 vcc, s75, v6
    v_mov_b32 v7, 1073741824
    s_nop 0
    v_cndmask_b32 v141, v7, v140, vcc
    v_lshlrev_b32 v226, 4, v1
    s_lshl_b32 s73, s67, 3
    s_add_u32 s73, s73, s69
    s_lshl_b32 s89, s73, 3
    s_add_u32 s89, s89, s64
    s_add_u32 s89, s89, s78
    s_lshl_b32 s74, s89, 10
    s_mul_i32 s93, s73, 12288
    s_add_u32 s93, s93, 851968
    s_waitcnt lgkmcnt(0)
    s_mov_b32 s28, s4
    s_mov_b32 s29, s5
    s_mov_b32 s30, 2097152
    s_mov_b32 s31, 0x20000
    s_cmp_eq_u32 s67, 0
    s_cselect_b32 s32, s6, s14
    s_cselect_b32 s33, s7, s15
    s_mov_b32 s34, 1409024
    s_cmov_b32 s34, 1572864
    s_mov_b32 s35, 0x20000
    buffer_load_dwordx4 v[8:11], v226, s[28:31], s74 offen
    s_add_u32 s100, s70, 0
    s_and_b32 s100, s100, 7
    s_mul_i32 s101, s100, s84
    s_lshl_b32 s100, s100, 7
    s_add_u32 m0, s76, 0
    s_nop 0
    buffer_load_dwordx4 v138, s[28:31], s100 offen lds
    s_add_u32 m0, s76, 1024
    s_nop 0
    buffer_load_dwordx4 v139, s[28:31], s100 offen lds
    s_add_u32 m0, s77, 16384
    s_add_u32 s74, s101, s81
    buffer_load_dwordx4 v140, s[32:35], s74 offen lds
    s_add_u32 m0, s77, 24576
    s_add_u32 s74, s101, s82
    buffer_load_dwordx4 v140, s[32:35], s74 offen lds
    s_add_u32 m0, s77, 32768
    s_add_u32 s74, s101, s83
    buffer_load_dwordx4 v141, s[32:35], s74 offen lds
    s_mov_b32 s56, s24
    s_mov_b32 s57, s25
    s_mov_b32 s58, 256
    s_mov_b32 s59, 0x20000
    v_cmp_eq_u32 vcc, 0, v1
    s_nop 1
    v_cndmask_b32 v198, v7, v1, vcc
    s_or_b32 s80, s98, 1
    v_mov_b32 v12, s80
    s_or_b32 s72, s2, s64
    s_cmp_eq_u32 s72, 0
    s_cselect_b32 s72, 0, 1073741824
    buffer_store_dword v12, v198, s[56:59], s72 offen sc1
    s_mov_b32 s36, s26
    s_mov_b32 s37, s27
    s_mov_b32 s38, 16777216
    s_mov_b32 s39, 0x20000
    s_mov_b32 s44, s18
    s_mov_b32 s45, s19
    s_mov_b32 s46, 1409024
    s_mov_b32 s47, 0x20000
    s_mov_b32 s48, s10
    s_mov_b32 s49, s11
    s_mov_b32 s50, 524288
    s_mov_b32 s51, 0x20000
    s_mov_b32 s52, s22
    s_mov_b32 s53, s23
    s_mov_b32 s54, 2097152
    s_mov_b32 s55, 0x20000
    s_mov_b32 s60, s20
    s_mov_b32 s61, s21
    s_mov_b32 s62, 1024
    s_mov_b32 s63, 0x20000
    s_cmp_eq_u32 s67, 0
    s_cselect_b32 s40, s8, s16
    s_cselect_b32 s41, s9, s17
    s_mov_b32 s42, 2752
    s_cmov_b32 s42, 16384
    s_mov_b32 s43, 0x20000
    s_lshl_b32 s79, s64, 4
    v_add_u32 v13, s79, v2
    v_lshlrev_b32 v13, 10, v13
    v_lshl_add_u32 v142, v6, 4, v13
    s_lshl_b32 s79, s86, 7
    v_add_u32 v142, s79, v142
    v_add_u32 v143, 0x2000, v142
    s_add_u32 s100, s70, 1
    s_and_b32 s100, s100, 7
    s_mul_i32 s101, s100, s84
    s_lshl_b32 s100, s100, 7
    s_add_u32 m0, s76, 40960
    s_nop 0
    buffer_load_dwordx4 v138, s[28:31], s100 offen lds
    s_add_u32 m0, s76, 41984
    s_nop 0
    buffer_load_dwordx4 v139, s[28:31], s100 offen lds
    s_add_u32 m0, s77, 57344
    s_add_u32 s74, s101, s81
    buffer_load_dwordx4 v140, s[32:35], s74 offen lds
    s_add_u32 m0, s77, 65536
    s_add_u32 s74, s101, s82
    buffer_load_dwordx4 v140, s[32:35], s74 offen lds
    s_add_u32 m0, s77, 73728
    s_add_u32 s74, s101, s83
    buffer_load_dwordx4 v141, s[32:35], s74 offen lds
    v_and_b32 v2, 31, v1
    v_lshrrev_b32 v3, 5, v1
    s_lshl_b32 s78, s65, 5
    v_add_u32 v4, s78, v2
    s_lshl_b32 s72, s68, 11
    s_lshl_b32 s73, s67, 15
    s_add_u32 s72, s72, s73
    s_add_u32 s72, s72, 786432
    v_lshlrev_b32 v5, 4, v4
    v_add_u32 v210, s72, v5
    v_lshlrev_b32 v219, 2, v4
    v_add_u32 v219, 114688, v219
    v_lshrrev_b32 v5, 1, v4
    v_and_b32 v5, 7, v5
    v_xor_b32 v5, v5, v3
    v_lshlrev_b32 v4, 7, v4
    v_xor_b32 v12, 0, v5
    v_lshl_add_u32 v128, v12, 4, v4
    v_add_u32 v132, 81920, v128
    v_xor_b32 v12, 2, v5
    v_lshl_add_u32 v129, v12, 4, v4
    v_add_u32 v133, 81920, v129
    v_xor_b32 v12, 4, v5
    v_lshl_add_u32 v130, v12, 4, v4
    v_add_u32 v134, 81920, v130
    v_xor_b32 v12, 6, v5
    v_lshl_add_u32 v131, v12, 4, v4
    v_add_u32 v135, 81920, v131
    v_bfe_u32 v12, v1, 4, 1
    v_bfe_u32 v13, v1, 1, 1
    v_lshl_add_u32 v12, v12, 1, v13
    v_bfe_u32 v13, v1, 3, 1
    v_lshl_add_u32 v12, v13, 2, v12
    v_lshlrev_b32 v12, 4, v12
    v_and_b32 v13, 1, v1
    v_lshl_add_u32 v12, v13, 3, v12
    v_bfe_u32 v13, v1, 2, 2
    v_lshl_add_u32 v14, v13, 7, v12
    s_lshl_b32 s72, s66, 6
    v_xor_b32 v12, s72, v14
    v_lshl_add_u32 v12, v3, 10, v12
    v_add_u32 v136, 16384, v12
    v_add_u32 v137, 98304, v12
    s_lshl_b32 s72, s65, 5
    v_xor_b32 v12, s72, v14
    s_lshl_b32 s72, s65, 12
    v_add_u32 v12, s72, v12
    v_lshl_add_u32 v227, v3, 9, v12
    v_xor_b32 v228, 64, v227
    v_lshl_add_u32 v229, v3, 11, v12
    v_xor_b32 v230, 64, v229
    s_lshl_b32 s72, s89, 4
    s_add_u32 s72, s72, 786432
    v_mov_b32 v12, s72
    v_cmp_eq_u32 vcc, 63, v1
    s_nop 1
    v_cndmask_b32 v208, v7, v12, vcc
    s_lshl_b32 s72, s66, 11
    v_lshl_add_u32 v12, v2, 4, s72
    v_lshl_add_u32 v211, v3, 9, v12
    s_lshl_b32 s72, s65, 12
    s_and_b32 s73, s68, 6
    s_lshl_b32 s73, s73, 8
    s_add_u32 s72, s72, s73
    s_and_b32 s73, s68, 1
    s_lshl_b32 s73, s73, 3
    s_add_u32 s72, s72, s73
    v_add_u32 v12, s72, v12
    v_cmp_gt_u32 vcc, 32, v1
    s_nop 1
    v_cndmask_b32 v209, v7, v12, vcc
    s_cmp_lt_u32 s68, 8
    s_cselect_b32 s89, s65, 3
    s_cmp_lt_u32 s89, 3
    s_cselect_b32 s94, s93, 1073741824
    v_mov_b32 v196, 0
    v_mov_b32 v175, 0
    v_mov_b32 v174, 0
    v_mov_b32 v179, 0
    v_mov_b32 v178, 0
    v_mov_b32 v183, 0
    v_mov_b32 v182, 0
    v_mov_b32 v187, 0
    v_mov_b32 v186, 0
    s_xor_b32 s72, s64, 1
    s_mul_i32 s72, s72, 6144
    s_add_u32 s72, s72, 65536
    v_add_u32 v231, s72, v226
    s_xor_b32 s72, s64, 2
    s_mul_i32 s72, s72, 6144
    s_add_u32 s72, s72, 67584
    v_add_u32 v232, s72, v226
    s_xor_b32 s72, s64, 3
    s_mul_i32 s72, s72, 6144
    s_add_u32 s72, s72, 69632
    v_add_u32 v233, s72, v226
    s_mul_i32 s72, s64, 6144
    s_add_u32 s72, s72, 65536
    v_add_u32 v234, s72, v226
    s_lshl_b32 s72, s86, 7
    s_lshl_b32 s73, s65, 5
    s_add_u32 s72, s72, s73
    s_lshl_b32 s73, s85, 16
    s_lshl_b32 s74, s66, 15
    s_add_u32 s73, s73, s74
    s_add_u32 s73, s73, s72
    v_lshl_add_u32 v253, v3, 3, s72
    v_lshl_add_u32 v13, v2, 10, s73
    v_lshl_add_u32 v235, v3, 4, v13
    v_lshlrev_b32 v225, 3, v0
    s_lshl_b32 s5, s69, 7
    s_add_u32 s5, s5, 65536
    s_lshl_b32 s72, s68, 2
    s_add_u32 s4, s5, s72
    s_lshl_b32 s6, s68, 7
    s_lshl_b32 s73, s69, 2
    s_add_u32 s6, s6, s73
    s_cmp_eq_u32 s67, 0
    s_mov_b32 s74, 69632
    s_cmov_b32 s74, 73728
    s_add_u32 s6, s6, s74
    s_lshr_b32 s7, s85, 1
    s_lshl_b32 s7, s7, 7
    s_add_u32 s7, s7, 69632
    s_mul_i32 s9, s69, 73728
    s_add_u32 s9, s9, 131072
    s_mul_i32 s8, s68, 4608
    s_add_u32 s8, s8, s9
    s_lshl_b32 s74, s85, 1
    s_add_u32 s74, s74, s66
    s_lshl_b32 s75, s65, 1
    s_mul_i32 s11, s74, 88
    s_add_u32 s11, s11, s75
    s_lshl_b32 s11, s11, 10
    s_add_u32 s11, s11, 1048576
    s_lshl_b32 s12, s74, 5
    s_add_u32 s12, s12, s75
    s_lshl_b32 s12, s12, 10
    s_add_u32 s12, s12, 8388608
    s_mov_b32 s91, 0x3f80
    s_mov_b32 s92, 0x3f800000
    s_mov_b32 s95, 0x3727c5ac
    s_sub_u32 s7, s7, 64
    v_mov_b32 v12, s5
    v_mov_b32 v13, s7
    v_cmp_gt_u32 vcc, 16, v1
    s_nop 1
    v_cndmask_b32 v12, v13, v12, vcc
    v_lshl_add_u32 v197, v1, 2, v12
    s_cmp_lg_u32 s67, 0
    s_cbranch_scc1 L_mlp
    v_bfe_u32 v12, v2, 2, 1
    s_lshl_b32 s72, s69, 2
    s_lshl_b32 s73, s66, 1
    s_add_u32 s72, s72, s73
    v_add_u32 v13, s72, v12
    v_lshlrev_b32 v13, 9, v13
    v_lshrrev_b32 v4, 3, v2
    v_and_b32 v5, 3, v2
    v_lshl_add_u32 v4, v4, 2, v5
    v_lshl_add_u32 v13, v4, 1, v13
    v_lshl_add_u32 v254, v3, 7, v13
    v_add_u32 v13, s73, v3
    v_lshl_add_u32 v5, v13, 4, v4
    v_lshlrev_b32 v5, 6, v5
    v_add_u32 v223, 114688, v5
    v_cmp_eq_u32 vcc, v12, v3
    s_mov_b64 s[20:21], vcc
    s_lshl_b32 s13, s69, 12
    s_add_u32 s13, s13, 720896
    v_lshlrev_b32 v5, 4, v4
    v_lshl_add_u32 v5, v13, 10, v5
    v_cndmask_b32 v224, v7, v5, vcc
    v_cmp_eq_u32 s[18:19], 0, v12
    s_lshl_b32 s10, s68, 2
    s_add_u32 s10, s10, s65
    s_lshl_b32 s10, s10, 5
    s_add_u32 s10, s10, s72
    s_lshl_b32 s10, s10, 10
    s_add_u32 s10, s10, 8388608
    s_lshl_b32 s78, s64, 12
    s_add_u32 s78, s78, 81920
    v_lshlrev_b32 v12, 11, v3
    v_lshl_add_u32 v12, v2, 6, v12
    v_add_u32 v12, s78, v12
    v_bfe_u32 v13, v2, 1, 2
    v_xor_b32 v5, 0, v13
    v_lshl_add_u32 v212, v5, 4, v12
    v_xor_b32 v5, 1, v13
    v_lshl_add_u32 v213, v5, 4, v12
    v_xor_b32 v5, 2, v13
    v_lshl_add_u32 v214, v5, 4, v12
    v_xor_b32 v5, 3, v13
    v_lshl_add_u32 v215, v5, 4, v12
    s_add_u32 s78, s76, 65536
    v_and_b32 v5, 15, v1
    v_lshl_add_u32 v12, v5, 4, s78
    v_lshl_add_u32 v12, v3, 8, v12
    v_bfe_u32 v13, v1, 4, 1
    v_lshl_add_u32 v216, v13, 10, v12
    v_bfe_u32 v12, v1, 2, 3
    v_lshl_add_u32 v6, v3, 4, v12
    v_lshrrev_b32 v12, 1, v12
    v_bfe_u32 v13, v1, 1, 1
    s_and_b32 s72, s64, 1
    s_lshl_b32 s73, s72, 1
    v_xor_b32 v12, v12, v13
    v_xor_b32 v12, s73, v12
    s_bfe_u32 s73, s64, 0x10001
    s_lshl_b32 s74, s73, 11
    s_lshl_b32 s75, s66, 14
    s_add_u32 s74, s74, s75
    s_add_u32 s74, s74, 81920
    v_lshl_add_u32 v6, v6, 6, s74
    v_lshl_add_u32 v6, v12, 4, v6
    v_and_b32 v12, 1, v1
    v_lshl_add_u32 v217, v12, 3, v6
    s_lshl_b32 s74, s73, 10
    s_lshl_b32 s75, s66, 13
    s_add_u32 s74, s74, s75
    s_add_u32 s74, s74, 65536
    v_add_u32 v218, s74, v226
    s_lshl_b32 s74, s65, 7
    s_add_u32 s74, s74, 114688
    v_lshl_add_u32 v220, v3, 4, s74
    v_bfe_u32 v6, v1, 4, 1
    s_lshl_b32 s74, s64, 9
    s_lshl_b32 s75, s68, 4
    s_add_u32 s74, s74, s75
    v_lshl_add_u32 v12, v6, 3, s74
    v_lshl_add_u32 v12, v3, 8, v12
    v_cmp_eq_u32 vcc, 0, v5
    s_nop 1
    v_cndmask_b32 v221, v7, v12, vcc
    s_lshr_b32 s74, s64, 1
    s_lshl_b32 s74, s74, 10
    s_lshl_b32 s72, s72, 5
    s_add_u32 s74, s74, s72
    s_add_u32 s74, s74, 114688
    v_lshl_add_u32 v6, v2, 1, v3
    v_and_b32 v5, 15, v6
    v_lshrrev_b32 v6, 4, v6
    v_lshl_add_u32 v12, v5, 6, s74
    v_lshl_add_u32 v222, v6, 3, v12
    s_lshl_b32 s74, s64, 9
    v_lshl_add_u32 v12, v2, 4, s74
    v_mul_u32_u24 v13, 36864, v3
    v_add_u32 v15, v12, v13
    v_and_b32 v12, 1, v1
    v_cmp_eq_u32 vcc, 0, v12
    s_nop 1
    v_cndmask_b32 v225, v7, v225, vcc
    s_waitcnt vmcnt(11)
    v_dot2_f32_bf16 v4, v8, s90, 0
    v_dot2_f32_bf16 v5, v8, v8, 0
    v_dot2_f32_bf16 v4, v9, s90, v4
    v_dot2_f32_bf16 v5, v9, v9, v5
    v_dot2_f32_bf16 v4, v10, s90, v4
    v_dot2_f32_bf16 v5, v10, v10, v5
    v_dot2_f32_bf16 v4, v11, s90, v4
    v_dot2_f32_bf16 v5, v11, v11, v5
    s_nop 1
    v_add_f32_dpp v4, v4, v4 quad_perm:[1,0,3,2] row_mask:0xf bank_mask:0xf
    v_add_f32_dpp v5, v5, v5 quad_perm:[1,0,3,2] row_mask:0xf bank_mask:0xf
    s_nop 0
    v_add_f32_dpp v4, v4, v4 quad_perm:[2,3,0,1] row_mask:0xf bank_mask:0xf
    v_add_f32_dpp v5, v5, v5 quad_perm:[2,3,0,1] row_mask:0xf bank_mask:0xf
    s_nop 0
    v_add_f32_dpp v4, v4, v4 row_half_mirror row_mask:0xf bank_mask:0xf
    v_add_f32_dpp v5, v5, v5 row_half_mirror row_mask:0xf bank_mask:0xf
    s_nop 0
    v_add_f32_dpp v4, v4, v4 row_mirror row_mask:0xf bank_mask:0xf
    v_add_f32_dpp v5, v5, v5 row_mirror row_mask:0xf bank_mask:0xf
    s_nop 0
    v_add_f32_dpp v4, v4, v4 row_bcast:15 row_mask:0xa bank_mask:0xf
    v_add_f32_dpp v5, v5, v5 row_bcast:15 row_mask:0xa bank_mask:0xf
    s_nop 0
    v_add_f32_dpp v4, v4, v4 row_bcast:31 row_mask:0xc bank_mask:0xf
    v_add_f32_dpp v5, v5, v5 row_bcast:31 row_mask:0xc bank_mask:0xf
    v_mul_f32 v4, 0xbb000000, v4
    v_mul_f32 v5, 0x3b000000, v5
    v_fma_f32 v5, -v4, v4, v5
    v_max_f32 v5, 0, v5
    v_add_f32 v6, s95, v5
    v_rsq_f32 v201, v6
    v_cvt_pk_bf16_f32 v6, v4, v4
    v_and_b32 v6, 0xffff0000, v6
    v_sub_f32 v6, v4, v6
    v_cvt_pk_bf16_f32 v200, v4, v6
    v_mov_b32 v204, v200
    v_mul_f32 v202, 0x3fb8aa3b, v201
    v_mul_f32 v5, v5, v201
    v_fma_f32 v5, v5, v201, s95
    v_rsq_f32 v5, v5
    s_nop 0
    v_mul_f32 v206, v5, v201
    v_rcp_f32 v5, v206
    s_nop 0
    v_cvt_pk_bf16_f32 v6, v5, v5
    v_and_b32 v6, 0xffff0000, v6
    v_sub_f32 v6, v5, v6
    v_cvt_pk_bf16_f32 v205, v5, v6
    buffer_load_dword v199, v198, s[56:59], 0 offen sc1
    s_add_u32 s100, s70, 2
    s_and_b32 s100, s100, 7
    s_mul_i32 s101, s100, s84
    s_lshl_b32 s100, s100, 7
    s_add_u32 m0, s76, 81920
    s_nop 0
    buffer_load_dwordx4 v138, s[28:31], s100 offen lds
    s_add_u32 m0, s76, 82944
    s_nop 0
    buffer_load_dwordx4 v139, s[28:31], s100 offen lds
    s_add_u32 m0, s77, 98304
    s_add_u32 s74, s101, s81
    buffer_load_dwordx4 v140, s[32:35], s74 offen lds
    s_add_u32 m0, s77, 106496
    s_add_u32 s74, s101, s82
    buffer_load_dwordx4 v140, s[32:35], s74 offen lds
    s_add_u32 m0, s77, 114688
    s_add_u32 s74, s101, s83
    buffer_load_dwordx4 v141, s[32:35], s74 offen lds
    s_waitcnt vmcnt(12)
    s_barrier
    ds_read_b128 v[64:67], v128 offset:0
    ds_read_b64_tr_b16 v[68:69], v136 offset:0
    ds_read_b64_tr_b16 v[70:71], v136 offset:512
    ds_read_b64_tr_b16 v[72:73], v136 offset:8192
    ds_read_b64_tr_b16 v[74:75], v136 offset:8704
    ds_read_b64_tr_b16 v[76:77], v136 offset:16384
    ds_read_b64_tr_b16 v[78:79], v136 offset:16896
    ds_read_b128 v[80:83], v129 offset:0
    ds_read_b64_tr_b16 v[84:85], v136 offset:2048
    ds_read_b64_tr_b16 v[86:87], v136 offset:2560
    ds_read_b64_tr_b16 v[88:89], v136 offset:10240
    ds_read_b64_tr_b16 v[90:91], v136 offset:10752
    ds_read_b64_tr_b16 v[92:93], v136 offset:18432
    ds_read_b64_tr_b16 v[94:95], v136 offset:18944
    s_waitcnt lgkmcnt(7)
    v_mfma_f32_32x32x16_bf16 v[16:31], v[68:71], v[64:67], 0
    ds_read_b128 v[96:99], v130 offset:0
    ds_read_b64_tr_b16 v[100:101], v136 offset:4096
    ds_read_b64_tr_b16 v[102:103], v136 offset:4608
    s_cmp_lg_u32 s89, 0
    s_cbranch_scc1 CD_1
    v_dot2_f32_bf16 v196, v68, s90, v196
    v_dot2_f32_bf16 v196, v69, s90, v196
    v_dot2_f32_bf16 v196, v70, s90, v196
    v_dot2_f32_bf16 v196, v71, s90, v196
CD_1:
    s_add_u32 s100, s70, 3
    s_and_b32 s100, s100, 7
    s_mul_i32 s101, s100, s84
    s_lshl_b32 s100, s100, 7
    s_add_u32 m0, s76, 122880
    s_nop 0
    buffer_load_dwordx4 v138, s[28:31], s100 offen lds
    v_mfma_f32_32x32x16_bf16 v[32:47], v[72:75], v[64:67], 0
    ds_read_b64_tr_b16 v[104:105], v136 offset:12288
    ds_read_b64_tr_b16 v[106:107], v136 offset:12800
    s_cmp_lg_u32 s89, 1
    s_cbranch_scc1 CD_2
    v_dot2_f32_bf16 v196, v72, s90, v196
    v_dot2_f32_bf16 v196, v73, s90, v196
    v_dot2_f32_bf16 v196, v74, s90, v196
    v_dot2_f32_bf16 v196, v75, s90, v196
CD_2:
    v_mfma_f32_32x32x16_bf16 v[48:63], v[64:67], v[76:79], 0
    ds_read_b64_tr_b16 v[108:109], v136 offset:20480
    ds_read_b64_tr_b16 v[110:111], v136 offset:20992
    s_cmp_lg_u32 s89, 2
    s_cbranch_scc1 CD_3
    v_dot2_f32_bf16 v196, v76, s90, v196
    v_dot2_f32_bf16 v196, v77, s90, v196
    v_dot2_f32_bf16 v196, v78, s90, v196
    v_dot2_f32_bf16 v196, v79, s90, v196
CD_3:
    s_add_u32 m0, s76, 123904
    s_nop 0
    buffer_load_dwordx4 v139, s[28:31], s100 offen lds
    s_waitcnt lgkmcnt(7)
    v_mfma_f32_32x32x16_bf16 v[16:31], v[84:87], v[80:83], v[16:31]
    ds_read_b128 v[112:115], v131 offset:0
    ds_read_b64_tr_b16 v[116:117], v136 offset:6144
    ds_read_b64_tr_b16 v[118:119], v136 offset:6656
    s_cmp_lg_u32 s89, 0
    s_cbranch_scc1 CD_4
    v_dot2_f32_bf16 v196, v84, s90, v196
    v_dot2_f32_bf16 v196, v85, s90, v196
    v_dot2_f32_bf16 v196, v86, s90, v196
    v_dot2_f32_bf16 v196, v87, s90, v196
CD_4:
    v_mfma_f32_32x32x16_bf16 v[32:47], v[88:91], v[80:83], v[32:47]
    ds_read_b64_tr_b16 v[120:121], v136 offset:14336
    ds_read_b64_tr_b16 v[122:123], v136 offset:14848
    s_cmp_lg_u32 s89, 1
    s_cbranch_scc1 CD_5
    v_dot2_f32_bf16 v196, v88, s90, v196
    v_dot2_f32_bf16 v196, v89, s90, v196
    v_dot2_f32_bf16 v196, v90, s90, v196
    v_dot2_f32_bf16 v196, v91, s90, v196
CD_5:
    s_add_u32 m0, s77, 139264
    s_add_u32 s74, s101, s81
    buffer_load_dwordx4 v140, s[32:35], s74 offen lds
    v_mfma_f32_32x32x16_bf16 v[48:63], v[80:83], v[92:95], v[48:63]
    ds_read_b64_tr_b16 v[124:125], v136 offset:22528
    ds_read_b64_tr_b16 v[126:127], v136 offset:23040
    s_cmp_lg_u32 s89, 2
    s_cbranch_scc1 CD_6
    v_dot2_f32_bf16 v196, v92, s90, v196
    v_dot2_f32_bf16 v196, v93, s90, v196
    v_dot2_f32_bf16 v196, v94, s90, v196
    v_dot2_f32_bf16 v196, v95, s90, v196
CD_6:
    s_waitcnt vmcnt(8) lgkmcnt(7)
    s_barrier
    v_mfma_f32_32x32x16_bf16 v[16:31], v[100:103], v[96:99], v[16:31]
    ds_read_b128 v[64:67], v128 offset:40960
    ds_read_b64_tr_b16 v[68:69], v136 offset:40960
    ds_read_b64_tr_b16 v[70:71], v136 offset:41472
    s_cmp_lg_u32 s89, 0
    s_cbranch_scc1 CD_7
    v_dot2_f32_bf16 v196, v100, s90, v196
    v_dot2_f32_bf16 v196, v101, s90, v196
    v_dot2_f32_bf16 v196, v102, s90, v196
    v_dot2_f32_bf16 v196, v103, s90, v196
CD_7:
    s_add_u32 m0, s77, 147456
    s_add_u32 s74, s101, s82
    buffer_load_dwordx4 v140, s[32:35], s74 offen lds
    v_mfma_f32_32x32x16_bf16 v[32:47], v[104:107], v[96:99], v[32:47]
    ds_read_b64_tr_b16 v[72:73], v136 offset:49152
    ds_read_b64_tr_b16 v[74:75], v136 offset:49664
    s_cmp_lg_u32 s89, 1
    s_cbranch_scc1 CD_8
    v_dot2_f32_bf16 v196, v104, s90, v196
    v_dot2_f32_bf16 v196, v105, s90, v196
    v_dot2_f32_bf16 v196, v106, s90, v196
    v_dot2_f32_bf16 v196, v107, s90, v196
CD_8:
    v_mfma_f32_32x32x16_bf16 v[48:63], v[96:99], v[108:111], v[48:63]
    ds_read_b64_tr_b16 v[76:77], v136 offset:57344
    ds_read_b64_tr_b16 v[78:79], v136 offset:57856
    s_cmp_lg_u32 s89, 2
    s_cbranch_scc1 CD_9
    v_dot2_f32_bf16 v196, v108, s90, v196
    v_dot2_f32_bf16 v196, v109, s90, v196
    v_dot2_f32_bf16 v196, v110, s90, v196
    v_dot2_f32_bf16 v196, v111, s90, v196
CD_9:
    s_add_u32 m0, s77, 155648
    s_add_u32 s74, s101, s83
    buffer_load_dwordx4 v141, s[32:35], s74 offen lds
    s_waitcnt lgkmcnt(7)
    v_mfma_f32_32x32x16_bf16 v[16:31], v[116:119], v[112:115], v[16:31]
    ds_read_b128 v[80:83], v129 offset:40960
    ds_read_b64_tr_b16 v[84:85], v136 offset:43008
    ds_read_b64_tr_b16 v[86:87], v136 offset:43520
    s_cmp_lg_u32 s89, 0
    s_cbranch_scc1 CD_10
    v_dot2_f32_bf16 v196, v116, s90, v196
    v_dot2_f32_bf16 v196, v117, s90, v196
    v_dot2_f32_bf16 v196, v118, s90, v196
    v_dot2_f32_bf16 v196, v119, s90, v196
CD_10:
    v_mfma_f32_32x32x16_bf16 v[32:47], v[120:123], v[112:115], v[32:47]
    ds_read_b64_tr_b16 v[88:89], v136 offset:51200
    ds_read_b64_tr_b16 v[90:91], v136 offset:51712
    s_cmp_lg_u32 s89, 1
    s_cbranch_scc1 CD_11
    v_dot2_f32_bf16 v196, v120, s90, v196
    v_dot2_f32_bf16 v196, v121, s90, v196
    v_dot2_f32_bf16 v196, v122, s90, v196
    v_dot2_f32_bf16 v196, v123, s90, v196
CD_11:
    v_mfma_f32_32x32x16_bf16 v[48:63], v[112:115], v[124:127], v[48:63]
    ds_read_b64_tr_b16 v[92:93], v136 offset:59392
    ds_read_b64_tr_b16 v[94:95], v136 offset:59904
    s_cmp_lg_u32 s89, 2
    s_cbranch_scc1 CD_12
    v_dot2_f32_bf16 v196, v124, s90, v196
    v_dot2_f32_bf16 v196, v125, s90, v196
    v_dot2_f32_bf16 v196, v126, s90, v196
    v_dot2_f32_bf16 v196, v127, s90, v196
CD_12:
    s_lshl_b32 s72, s2, 13
    s_add_u32 s72, s72, s77
    s_sub_u32 s73, s72, 1409024
    s_cmp_lt_u32 s72, 1409024
    s_cbranch_scc0 L_pfo0
    buffer_load_dwordx4 v[8:11], v226, s[44:47], s72 offen
    s_branch L_pfd0
L_pfo0:
    buffer_load_dwordx4 v[8:11], v226, s[48:51], s73 offen
L_pfd0:
    s_waitcnt lgkmcnt(7)
    v_mfma_f32_32x32x16_bf16 v[16:31], v[68:71], v[64:67], v[16:31]
    ds_read_b128 v[96:99], v130 offset:40960
    ds_read_b64_tr_b16 v[100:101], v136 offset:45056
    ds_read_b64_tr_b16 v[102:103], v136 offset:45568
    v_mfma_f32_32x32x16_bf16 v[32:47], v[72:75], v[64:67], v[32:47]
    ds_read_b64_tr_b16 v[104:105], v136 offset:53248
    ds_read_b64_tr_b16 v[106:107], v136 offset:53760
    v_readfirstlane_b32 s80, v199
    s_mov_b32 s73, 0
EP_13:
    s_cmp_lg_u32 s80, 0
    s_cbranch_scc1 EP_13d
    s_add_u32 s73, s73, 1
    s_cmp_gt_u32 s73, 20000
    s_cbranch_scc1 EP_13d
    buffer_load_dword v199, v198, s[56:59], 0 offen sc1
    s_waitcnt vmcnt(0)
    v_readfirstlane_b32 s80, v199
    s_branch EP_13
EP_13d:
    v_mov_b32 v4, v196
    v_mov_b32 v203, s80
    v_mov_b32 v207, s80
    v_permlane32_swap_b32 v4, v196
    v_mov_b32 v5, s80
    s_mov_b32 s72, 0x8000
    v_add_f32 v4, v4, v196
    buffer_store_dwordx4 v[200:203], v208, s[36:39], 0 offen sc1
    buffer_store_dwordx4 v[204:207], v208, s[36:39], s72 offen sc1
    buffer_store_dwordx2 v[4:5], v209, s[36:39], s94 offen sc1
    v_mfma_f32_32x32x16_bf16 v[48:63], v[64:67], v[76:79], v[48:63]
    ds_read_b64_tr_b16 v[108:109], v136 offset:61440
    ds_read_b64_tr_b16 v[110:111], v136 offset:61952
    s_waitcnt lgkmcnt(7)
    v_mfma_f32_32x32x16_bf16 v[16:31], v[84:87], v[80:83], v[16:31]
    ds_read_b128 v[112:115], v131 offset:40960
    ds_read_b64_tr_b16 v[116:117], v136 offset:47104
    ds_read_b64_tr_b16 v[118:119], v136 offset:47616
    buffer_load_ushort v148, v254, s[40:43], 0 offen offset:0
    v_mfma_f32_32x32x16_bf16 v[32:47], v[88:91], v[80:83], v[32:47]
    ds_read_b64_tr_b16 v[120:121], v136 offset:55296
    ds_read_b64_tr_b16 v[122:123], v136 offset:55808
    v_mfma_f32_32x32x16_bf16 v[48:63], v[80:83], v[92:95], v[48:63]
    ds_read_b64_tr_b16 v[124:125], v136 offset:63488
    ds_read_b64_tr_b16 v[126:127], v136 offset:64000
    buffer_load_ushort v149, v254, s[40:43], 0 offen offset:32
    s_waitcnt vmcnt(11) lgkmcnt(7)
    s_barrier
    v_mfma_f32_32x32x16_bf16 v[16:31], v[100:103], v[96:99], v[16:31]
    ds_read_b128 v[64:67], v132 offset:0
    ds_read_b64_tr_b16 v[68:69], v137 offset:0
    ds_read_b64_tr_b16 v[70:71], v137 offset:512
    s_add_u32 s100, s70, 4
    s_and_b32 s100, s100, 7
    s_mul_i32 s101, s100, s84
    s_lshl_b32 s100, s100, 7
    s_add_u32 m0, s76, 0
    s_nop 0
    buffer_load_dwordx4 v138, s[28:31], s100 offen lds
    v_mfma_f32_32x32x16_bf16 v[32:47], v[104:107], v[96:99], v[32:47]
    ds_read_b64_tr_b16 v[72:73], v137 offset:8192
    ds_read_b64_tr_b16 v[74:75], v137 offset:8704
    buffer_load_ushort v150, v254, s[40:43], 0 offen offset:64
    v_mfma_f32_32x32x16_bf16 v[48:63], v[96:99], v[108:111], v[48:63]
    ds_read_b64_tr_b16 v[76:77], v137 offset:16384
    ds_read_b64_tr_b16 v[78:79], v137 offset:16896
    s_add_u32 m0, s76, 1024
    s_nop 0
    buffer_load_dwordx4 v139, s[28:31], s100 offen lds
    s_waitcnt lgkmcnt(7)
    v_mfma_f32_32x32x16_bf16 v[16:31], v[116:119], v[112:115], v[16:31]
    ds_read_b128 v[80:83], v133 offset:0
    ds_read_b64_tr_b16 v[84:85], v137 offset:2048
    ds_read_b64_tr_b16 v[86:87], v137 offset:2560
    buffer_load_ushort v151, v254, s[40:43], 0 offen offset:96
    v_mfma_f32_32x32x16_bf16 v[32:47], v[120:123], v[112:115], v[32:47]
    ds_read_b64_tr_b16 v[88:89], v137 offset:10240
    ds_read_b64_tr_b16 v[90:91], v137 offset:10752
    s_add_u32 m0, s77, 16384
    s_add_u32 s74, s101, s81
    buffer_load_dwordx4 v140, s[32:35], s74 offen lds
    v_mfma_f32_32x32x16_bf16 v[48:63], v[112:115], v[124:127], v[48:63]
    ds_read_b64_tr_b16 v[92:93], v137 offset:18432
    ds_read_b64_tr_b16 v[94:95], v137 offset:18944
    buffer_load_ushort v152, v254, s[40:43], 0 offen offset:256
    s_waitcnt lgkmcnt(7)
    v_mfma_f32_32x32x16_bf16 v[16:31], v[68:71], v[64:67], v[16:31]
    ds_read_b128 v[96:99], v134 offset:0
    ds_read_b64_tr_b16 v[100:101], v137 offset:4096
    ds_read_b64_tr_b16 v[102:103], v137 offset:4608
    s_add_u32 m0, s77, 24576
    s_add_u32 s74, s101, s82
    buffer_load_dwordx4 v140, s[32:35], s74 offen lds
    v_mfma_f32_32x32x16_bf16 v[32:47], v[72:75], v[64:67], v[32:47]
    ds_read_b64_tr_b16 v[104:105], v137 offset:12288
    ds_read_b64_tr_b16 v[106:107], v137 offset:12800
    buffer_load_ushort v153, v254, s[40:43], 0 offen offset:288
    v_mfma_f32_32x32x16_bf16 v[48:63], v[64:67], v[76:79], v[48:63]
    ds_read_b64_tr_b16 v[108:109], v137 offset:20480
    ds_read_b64_tr_b16 v[110:111], v137 offset:20992
    s_add_u32 m0, s77, 32768
    s_add_u32 s74, s101, s83
    buffer_load_dwordx4 v141, s[32:35], s74 offen lds
    s_waitcnt lgkmcnt(7)
    v_mfma_f32_32x32x16_bf16 v[16:31], v[84:87], v[80:83], v[16:31]
    ds_read_b128 v[112:115], v135 offset:0
    ds_read_b64_tr_b16 v[116:117], v137 offset:6144
    ds_read_b64_tr_b16 v[118:119], v137 offset:6656
    buffer_load_ushort v154, v254, s[40:43], 0 offen offset:320
    v_mfma_f32_32x32x16_bf16 v[32:47], v[88:91], v[80:83], v[32:47]
    ds_read_b64_tr_b16 v[120:121], v137 offset:14336
    ds_read_b64_tr_b16 v[122:123], v137 offset:14848
    v_mfma_f32_32x32x16_bf16 v[48:63], v[80:83], v[92:95], v[48:63]
    ds_read_b64_tr_b16 v[124:125], v137 offset:22528
    ds_read_b64_tr_b16 v[126:127], v137 offset:23040
    buffer_load_ushort v155, v254, s[40:43], 0 offen offset:352
    s_waitcnt vmcnt(17) lgkmcnt(7)
    s_barrier
    v_mfma_f32_32x32x16_bf16 v[16:31], v[100:103], v[96:99], v[16:31]
    ds_read_b128 v[64:67], v132 offset:40960
    ds_read_b64_tr_b16 v[68:69], v137 offset:40960
    ds_read_b64_tr_b16 v[70:71], v137 offset:41472
    s_add_u32 s100, s70, 5
    s_and_b32 s100, s100, 7
    s_mul_i32 s101, s100, s84
    s_lshl_b32 s100, s100, 7
    s_add_u32 m0, s76, 40960
    s_nop 0
    buffer_load_dwordx4 v138, s[28:31], s100 offen lds
    v_mfma_f32_32x32x16_bf16 v[32:47], v[104:107], v[96:99], v[32:47]
    ds_read_b64_tr_b16 v[72:73], v137 offset:49152
    ds_read_b64_tr_b16 v[74:75], v137 offset:49664
    buffer_load_dwordx4 v[236:239], v235, s[28:31], 0 offen
    v_mfma_f32_32x32x16_bf16 v[48:63], v[96:99], v[108:111], v[48:63]
    ds_read_b64_tr_b16 v[76:77], v137 offset:57344
    ds_read_b64_tr_b16 v[78:79], v137 offset:57856
    s_add_u32 m0, s76, 41984
    s_nop 0
    buffer_load_dwordx4 v139, s[28:31], s100 offen lds
    s_waitcnt lgkmcnt(7)
    v_mfma_f32_32x32x16_bf16 v[16:31], v[116:119], v[112:115], v[16:31]
    ds_read_b128 v[80:83], v133 offset:40960
    ds_read_b64_tr_b16 v[84:85], v137 offset:43008
    ds_read_b64_tr_b16 v[86:87], v137 offset:43520
    buffer_load_dwordx2 v[244:245], v253, s[60:63], 0 offen offset:0
    v_mfma_f32_32x32x16_bf16 v[32:47], v[120:123], v[112:115], v[32:47]
    ds_read_b64_tr_b16 v[88:89], v137 offset:51200
    ds_read_b64_tr_b16 v[90:91], v137 offset:51712
    s_add_u32 m0, s77, 57344
    s_add_u32 s74, s101, s81
    buffer_load_dwordx4 v140, s[32:35], s74 offen lds
    v_mfma_f32_32x32x16_bf16 v[48:63], v[112:115], v[124:127], v[48:63]
    ds_read_b64_tr_b16 v[92:93], v137 offset:59392
    ds_read_b64_tr_b16 v[94:95], v137 offset:59904
    buffer_load_dwordx2 v[248:249], v253, s[60:63], 0 offen offset:16
    s_waitcnt lgkmcnt(7)
    v_mfma_f32_32x32x16_bf16 v[16:31], v[68:71], v[64:67], v[16:31]
    ds_read_b128 v[96:99], v134 offset:40960
    ds_read_b64_tr_b16 v[100:101], v137 offset:45056
    ds_read_b64_tr_b16 v[102:103], v137 offset:45568
    s_add_u32 m0, s77, 65536
    s_add_u32 s74, s101, s82
    buffer_load_dwordx4 v140, s[32:35], s74 offen lds
    v_mfma_f32_32x32x16_bf16 v[32:47], v[72:75], v[64:67], v[32:47]
    ds_read_b64_tr_b16 v[104:105], v137 offset:53248
    ds_read_b64_tr_b16 v[106:107], v137 offset:53760
    v_mfma_f32_32x32x16_bf16 v[48:63], v[64:67], v[76:79], v[48:63]
    ds_read_b64_tr_b16 v[108:109], v137 offset:61440
    ds_read_b64_tr_b16 v[110:111], v137 offset:61952
    s_add_u32 m0, s77, 73728
    s_add_u32 s74, s101, s83
    buffer_load_dwordx4 v141, s[32:35], s74 offen lds
    s_waitcnt lgkmcnt(7)
    v_mfma_f32_32x32x16_bf16 v[16:31], v[84:87], v[80:83], v[16:31]
    ds_read_b128 v[112:115], v135 offset:40960
    ds_read_b64_tr_b16 v[116:117], v137 offset:47104
    ds_read_b64_tr_b16 v[118:119], v137 offset:47616
    v_mfma_f32_32x32x16_bf16 v[32:47], v[88:91], v[80:83], v[32:47]
    ds_read_b64_tr_b16 v[120:121], v137 offset:55296
    ds_read_b64_tr_b16 v[122:123], v137 offset:55808
    v_mfma_f32_32x32x16_bf16 v[48:63], v[80:83], v[92:95], v[48:63]
    ds_read_b64_tr_b16 v[124:125], v137 offset:63488
    ds_read_b64_tr_b16 v[126:127], v137 offset:64000
    s_waitcnt vmcnt(10) lgkmcnt(7)
    s_barrier
    v_mfma_f32_32x32x16_bf16 v[16:31], v[100:103], v[96:99], v[16:31]
    ds_read_b128 v[64:67], v128 offset:0
    ds_read_b64_tr_b16 v[68:69], v136 offset:0
    ds_read_b64_tr_b16 v[70:71], v136 offset:512
    s_add_u32 s100, s70, 6
    s_and_b32 s100, s100, 7
    s_mul_i32 s101, s100, s84
    s_lshl_b32 s100, s100, 7
    s_add_u32 m0, s76, 81920
    s_nop 0
    buffer_load_dwordx4 v138, s[28:31], s100 offen lds
    v_mfma_f32_32x32x16_bf16 v[32:47], v[104:107], v[96:99], v[32:47]
    ds_read_b64_tr_b16 v[72:73], v136 offset:8192
    ds_read_b64_tr_b16 v[74:75], v136 offset:8704
    v_mfma_f32_32x32x16_bf16 v[48:63], v[96:99], v[108:111], v[48:63]
    ds_read_b64_tr_b16 v[76:77], v136 offset:16384
    ds_read_b64_tr_b16 v[78:79], v136 offset:16896
    s_add_u32 m0, s76, 82944
    s_nop 0
    buffer_load_dwordx4 v139, s[28:31], s100 offen lds
    s_waitcnt lgkmcnt(7)
    v_mfma_f32_32x32x16_bf16 v[16:31], v[116:119], v[112:115], v[16:31]
    ds_read_b128 v[80:83], v129 offset:0
    ds_read_b64_tr_b16 v[84:85], v136 offset:2048
    ds_read_b64_tr_b16 v[86:87], v136 offset:2560
    v_mfma_f32_32x32x16_bf16 v[32:47], v[120:123], v[112:115], v[32:47]
    ds_read_b64_tr_b16 v[88:89], v136 offset:10240
    ds_read_b64_tr_b16 v[90:91], v136 offset:10752
    s_add_u32 m0, s77, 98304
    s_add_u32 s74, s101, s81
    buffer_load_dwordx4 v140, s[32:35], s74 offen lds
    v_mfma_f32_32x32x16_bf16 v[48:63], v[112:115], v[124:127], v[48:63]
    ds_read_b64_tr_b16 v[92:93], v136 offset:18432
    ds_read_b64_tr_b16 v[94:95], v136 offset:18944
    s_waitcnt lgkmcnt(7)
    v_mfma_f32_32x32x16_bf16 v[16:31], v[68:71], v[64:67], v[16:31]
    ds_read_b128 v[96:99], v130 offset:0
    ds_read_b64_tr_b16 v[100:101], v136 offset:4096
    ds_read_b64_tr_b16 v[102:103], v136 offset:4608
    s_add_u32 m0, s77, 106496
    s_add_u32 s74, s101, s82
    buffer_load_dwordx4 v140, s[32:35], s74 offen lds
    v_mfma_f32_32x32x16_bf16 v[32:47], v[72:75], v[64:67], v[32:47]
    ds_read_b64_tr_b16 v[104:105], v136 offset:12288
    ds_read_b64_tr_b16 v[106:107], v136 offset:12800
    v_mfma_f32_32x32x16_bf16 v[48:63], v[64:67], v[76:79], v[48:63]
    ds_read_b64_tr_b16 v[108:109], v136 offset:20480
    ds_read_b64_tr_b16 v[110:111], v136 offset:20992
    s_add_u32 m0, s77, 114688
    s_add_u32 s74, s101, s83
    buffer_load_dwordx4 v141, s[32:35], s74 offen lds
    s_waitcnt lgkmcnt(7)
    v_mfma_f32_32x32x16_bf16 v[16:31], v[84:87], v[80:83], v[16:31]
    ds_read_b128 v[112:115], v131 offset:0
    ds_read_b64_tr_b16 v[116:117], v136 offset:6144
    ds_read_b64_tr_b16 v[118:119], v136 offset:6656
    v_mfma_f32_32x32x16_bf16 v[32:47], v[88:91], v[80:83], v[32:47]
    ds_read_b64_tr_b16 v[120:121], v136 offset:14336
    ds_read_b64_tr_b16 v[122:123], v136 offset:14848
    v_mfma_f32_32x32x16_bf16 v[48:63], v[80:83], v[92:95], v[48:63]
    ds_read_b64_tr_b16 v[124:125], v136 offset:22528
    ds_read_b64_tr_b16 v[126:127], v136 offset:23040
    s_waitcnt vmcnt(5) lgkmcnt(7)
    s_barrier
    v_mfma_f32_32x32x16_bf16 v[16:31], v[100:103], v[96:99], v[16:31]
    ds_read_b128 v[64:67], v128 offset:40960
    ds_read_b64_tr_b16 v[68:69], v136 offset:40960
    ds_read_b64_tr_b16 v[70:71], v136 offset:41472
    s_add_u32 s100, s70, 7
    s_and_b32 s100, s100, 7
    s_mul_i32 s101, s100, s84
    s_lshl_b32 s100, s100, 7
    s_add_u32 m0, s76, 122880
    s_nop 0
    buffer_load_dwordx4 v138, s[28:31], s100 offen lds
    v_mfma_f32_32x32x16_bf16 v[32:47], v[104:107], v[96:99], v[32:47]
    ds_read_b64_tr_b16 v[72:73], v136 offset:49152
    ds_read_b64_tr_b16 v[74:75], v136 offset:49664
    v_lshl_or_b32 v14, v149, 16, v148
    v_cndmask_b32 v188, 0, v14, s[18:19]
    v_cndmask_b32 v192, v14, 0, s[18:19]
    v_mfma_f32_32x32x16_bf16 v[48:63], v[96:99], v[108:111], v[48:63]
    ds_read_b64_tr_b16 v[76:77], v136 offset:57344
    ds_read_b64_tr_b16 v[78:79], v136 offset:57856
    s_add_u32 m0, s76, 123904
    s_nop 0
    buffer_load_dwordx4 v139, s[28:31], s100 offen lds
    v_lshl_or_b32 v14, v151, 16, v150
    v_cndmask_b32 v189, 0, v14, s[18:19]
    s_waitcnt lgkmcnt(7)
    v_mfma_f32_32x32x16_bf16 v[16:31], v[116:119], v[112:115], v[16:31]
    ds_read_b128 v[80:83], v129 offset:40960
    ds_read_b64_tr_b16 v[84:85], v136 offset:43008
    ds_read_b64_tr_b16 v[86:87], v136 offset:43520
    v_cndmask_b32 v193, v14, 0, s[18:19]
    v_lshl_or_b32 v14, v153, 16, v152
    v_cndmask_b32 v190, 0, v14, s[18:19]
    v_mfma_f32_32x32x16_bf16 v[32:47], v[120:123], v[112:115], v[32:47]
    ds_read_b64_tr_b16 v[88:89], v136 offset:51200
    ds_read_b64_tr_b16 v[90:91], v136 offset:51712
    s_add_u32 m0, s77, 139264
    s_add_u32 s74, s101, s81
    buffer_load_dwordx4 v140, s[32:35], s74 offen lds
    v_cndmask_b32 v194, v14, 0, s[18:19]
    v_lshl_or_b32 v14, v155, 16, v154
    v_mfma_f32_32x32x16_bf16 v[48:63], v[112:115], v[124:127], v[48:63]
    ds_read_b64_tr_b16 v[92:93], v136 offset:59392
    ds_read_b64_tr_b16 v[94:95], v136 offset:59904
    v_cndmask_b32 v191, 0, v14, s[18:19]
    v_cndmask_b32 v195, v14, 0, s[18:19]
    v_mov_b32 v196, v15
    s_waitcnt lgkmcnt(7)
    v_mfma_f32_32x32x16_bf16 v[16:31], v[68:71], v[64:67], v[16:31]
    ds_read_b128 v[96:99], v130 offset:40960
    ds_read_b64_tr_b16 v[100:101], v136 offset:45056
    ds_read_b64_tr_b16 v[102:103], v136 offset:45568
    s_add_u32 m0, s77, 147456
    s_add_u32 s74, s101, s82
    buffer_load_dwordx4 v140, s[32:35], s74 offen lds
    v_permlane32_swap_b32 v236, v238
    v_permlane32_swap_b32 v237, v239
    v_mfma_f32_32x32x16_bf16 v[32:47], v[72:75], v[64:67], v[32:47]
    ds_read_b64_tr_b16 v[104:105], v136 offset:53248
    ds_read_b64_tr_b16 v[106:107], v136 offset:53760
    v_and_b32 v247, 0xffff0000, v245
    v_lshlrev_b32 v246, 16, v245
    v_and_b32 v245, 0xffff0000, v244
    v_mfma_f32_32x32x16_bf16 v[48:63], v[64:67], v[76:79], v[48:63]
    ds_read_b64_tr_b16 v[108:109], v136 offset:61440
    ds_read_b64_tr_b16 v[110:111], v136 offset:61952
    s_add_u32 m0, s77, 155648
    s_add_u32 s74, s101, s83
    buffer_load_dwordx4 v141, s[32:35], s74 offen lds
    v_lshlrev_b32 v244, 16, v244
    v_and_b32 v243, 0xffff0000, v239
    s_waitcnt lgkmcnt(7)
    v_mfma_f32_32x32x16_bf16 v[16:31], v[84:87], v[80:83], v[16:31]
    ds_read_b128 v[112:115], v131 offset:40960
    ds_read_b64_tr_b16 v[116:117], v136 offset:47104
    ds_read_b64_tr_b16 v[118:119], v136 offset:47616
    v_lshlrev_b32 v242, 16, v239
    v_and_b32 v241, 0xffff0000, v238
    v_lshlrev_b32 v240, 16, v238
    v_mfma_f32_32x32x16_bf16 v[32:47], v[88:91], v[80:83], v[32:47]
    ds_read_b64_tr_b16 v[120:121], v136 offset:55296
    ds_read_b64_tr_b16 v[122:123], v136 offset:55808
    v_and_b32 v239, 0xffff0000, v237
    v_lshlrev_b32 v238, 16, v237
    v_mfma_f32_32x32x16_bf16 v[48:63], v[80:83], v[92:95], v[48:63]
    ds_read_b64_tr_b16 v[124:125], v136 offset:63488
    ds_read_b64_tr_b16 v[126:127], v136 offset:64000
    v_and_b32 v237, 0xffff0000, v236
    v_lshlrev_b32 v236, 16, v236
    v_and_b32 v251, 0xffff0000, v249
    s_waitcnt vmcnt(5) lgkmcnt(7)
    s_barrier
    v_mfma_f32_32x32x16_bf16 v[16:31], v[100:103], v[96:99], v[16:31]
    ds_read_b128 v[64:67], v132 offset:0
    ds_read_b64_tr_b16 v[68:69], v137 offset:0
    ds_read_b64_tr_b16 v[70:71], v137 offset:512
    v_lshlrev_b32 v250, 16, v249
    v_and_b32 v249, 0xffff0000, v248
    s_mov_b32 s72, 0
    s_add_u32 m0, s76, 0
    s_nop 0
    buffer_load_dwordx4 v142, s[44:47], s72 offen lds
    v_mfma_f32_32x32x16_bf16 v[32:47], v[104:107], v[96:99], v[32:47]
    ds_read_b64_tr_b16 v[72:73], v137 offset:8192
    ds_read_b64_tr_b16 v[74:75], v137 offset:8704
    v_lshlrev_b32 v248, 16, v248
    s_mov_b32 s72, 0
    s_add_u32 m0, s76, 1024
    s_nop 0
    buffer_load_dwordx4 v143, s[44:47], s72 offen lds
    v_mfma_f32_32x32x16_bf16 v[48:63], v[96:99], v[108:111], v[48:63]
    ds_read_b64_tr_b16 v[76:77], v137 offset:16384
    ds_read_b64_tr_b16 v[78:79], v137 offset:16896
    s_mov_b32 s72, 131072
    s_add_u32 m0, s76, 16384
    s_nop 0
    buffer_load_dwordx4 v142, s[44:47], s72 offen lds
    s_waitcnt lgkmcnt(7)
    v_mfma_f32_32x32x16_bf16 v[16:31], v[116:119], v[112:115], v[16:31]
    ds_read_b128 v[80:83], v133 offset:0
    ds_read_b64_tr_b16 v[84:85], v137 offset:2048
    ds_read_b64_tr_b16 v[86:87], v137 offset:2560
    s_mov_b32 s72, 131072
    s_add_u32 m0, s76, 17408
    s_nop 0
    buffer_load_dwordx4 v143, s[44:47], s72 offen lds
    v_mfma_f32_32x32x16_bf16 v[32:47], v[120:123], v[112:115], v[32:47]
    ds_read_b64_tr_b16 v[88:89], v137 offset:10240
    ds_read_b64_tr_b16 v[90:91], v137 offset:10752
    buffer_load_dwordx4 v[144:147], v210, s[36:39], 0 offen sc1
    v_mfma_f32_32x32x16_bf16 v[48:63], v[112:115], v[124:127], v[48:63]
    ds_read_b64_tr_b16 v[92:93], v137 offset:18432
    ds_read_b64_tr_b16 v[94:95], v137 offset:18944
    s_add_u32 s72, s93, 0
    buffer_load_dwordx4 v[148:151], v211, s[36:39], s72 offen offset:0 sc1
    s_waitcnt lgkmcnt(7)
    v_mfma_f32_32x32x16_bf16 v[16:31], v[68:71], v[64:67], v[16:31]
    ds_read_b128 v[96:99], v134 offset:0
    ds_read_b64_tr_b16 v[100:101], v137 offset:4096
    ds_read_b64_tr_b16 v[102:103], v137 offset:4608
    s_add_u32 s72, s93, 0
    buffer_load_dwordx4 v[152:155], v211, s[36:39], s72 offen offset:1024 sc1
    v_mfma_f32_32x32x16_bf16 v[32:47], v[72:75], v[64:67], v[32:47]
    ds_read_b64_tr_b16 v[104:105], v137 offset:12288
    ds_read_b64_tr_b16 v[106:107], v137 offset:12800
    s_add_u32 s72, s93, 4096
    buffer_load_dwordx4 v[156:159], v211, s[36:39], s72 offen offset:0 sc1
    v_mfma_f32_32x32x16_bf16 v[48:63], v[64:67], v[76:79], v[48:63]
    ds_read_b64_tr_b16 v[108:109], v137 offset:20480
    ds_read_b64_tr_b16 v[110:111], v137 offset:20992
    s_add_u32 s72, s93, 4096
    buffer_load_dwordx4 v[160:163], v211, s[36:39], s72 offen offset:1024 sc1
    s_waitcnt lgkmcnt(7)
    v_mfma_f32_32x32x16_bf16 v[16:31], v[84:87], v[80:83], v[16:31]
    ds_read_b128 v[112:115], v135 offset:0
    ds_read_b64_tr_b16 v[116:117], v137 offset:6144
    ds_read_b64_tr_b16 v[118:119], v137 offset:6656
    s_add_u32 s72, s93, 8192
    buffer_load_dwordx4 v[164:167], v211, s[36:39], s72 offen offset:0 sc1
    v_mfma_f32_32x32x16_bf16 v[32:47], v[88:91], v[80:83], v[32:47]
    ds_read_b64_tr_b16 v[120:121], v137 offset:14336
    ds_read_b64_tr_b16 v[122:123], v137 offset:14848
    s_add_u32 s72, s93, 8192
    buffer_load_dwordx4 v[168:171], v211, s[36:39], s72 offen offset:1024 sc1
    v_mfma_f32_32x32x16_bf16 v[48:63], v[80:83], v[92:95], v[48:63]
    ds_read_b64_tr_b16 v[124:125], v137 offset:22528
    ds_read_b64_tr_b16 v[126:127], v137 offset:23040
    s_waitcnt vmcnt(11) lgkmcnt(7)
    s_barrier
    v_mfma_f32_32x32x16_bf16 v[16:31], v[100:103], v[96:99], v[16:31]
    ds_read_b128 v[64:67], v132 offset:40960
    ds_read_b64_tr_b16 v[68:69], v137 offset:40960
    ds_read_b64_tr_b16 v[70:71], v137 offset:41472
    s_mov_b32 s72, 262144
    s_add_u32 m0, s76, 32768
    s_nop 0
    buffer_load_dwordx4 v142, s[44:47], s72 offen lds
    v_mfma_f32_32x32x16_bf16 v[32:47], v[104:107], v[96:99], v[32:47]
    ds_read_b64_tr_b16 v[72:73], v137 offset:49152
    ds_read_b64_tr_b16 v[74:75], v137 offset:49664
    v_mfma_f32_32x32x16_bf16 v[48:63], v[96:99], v[108:111], v[48:63]
    ds_read_b64_tr_b16 v[76:77], v137 offset:57344
    ds_read_b64_tr_b16 v[78:79], v137 offset:57856
    s_mov_b32 s72, 262144
    s_add_u32 m0, s76, 33792
    s_nop 0
    buffer_load_dwordx4 v143, s[44:47], s72 offen lds
    s_waitcnt lgkmcnt(7)
    v_mfma_f32_32x32x16_bf16 v[16:31], v[116:119], v[112:115], v[16:31]
    ds_read_b128 v[80:83], v133 offset:40960
    ds_read_b64_tr_b16 v[84:85], v137 offset:43008
    ds_read_b64_tr_b16 v[86:87], v137 offset:43520
    v_mfma_f32_32x32x16_bf16 v[32:47], v[120:123], v[112:115], v[32:47]
    ds_read_b64_tr_b16 v[88:89], v137 offset:51200
    ds_read_b64_tr_b16 v[90:91], v137 offset:51712
    s_mov_b32 s72, 393216
    s_add_u32 m0, s76, 49152
    s_nop 0
    buffer_load_dwordx4 v142, s[44:47], s72 offen lds
    v_mfma_f32_32x32x16_bf16 v[48:63], v[112:115], v[124:127], v[48:63]
    ds_read_b64_tr_b16 v[92:93], v137 offset:59392
    ds_read_b64_tr_b16 v[94:95], v137 offset:59904
    s_waitcnt vmcnt(3) lgkmcnt(7)
    v_mfma_f32_32x32x16_bf16 v[16:31], v[68:71], v[64:67], v[16:31]
    ds_read_b128 v[96:99], v134 offset:40960
    ds_read_b64_tr_b16 v[100:101], v137 offset:45056
    ds_read_b64_tr_b16 v[102:103], v137 offset:45568
    s_mov_b32 s72, 393216
    s_add_u32 m0, s76, 50176
    s_nop 0
    buffer_load_dwordx4 v143, s[44:47], s72 offen lds
    v_min3_u32 v4, v147, v149, v151
    v_max3_u32 v5, v147, v149, v151
    v_min3_u32 v4, v4, v153, v155
    v_max3_u32 v5, v5, v153, v155
    v_min3_u32 v4, v4, v157, v159
    v_mfma_f32_32x32x16_bf16 v[32:47], v[72:75], v[64:67], v[32:47]
    ds_read_b64_tr_b16 v[104:105], v137 offset:53248
    ds_read_b64_tr_b16 v[106:107], v137 offset:53760
    v_max3_u32 v5, v5, v157, v159
    v_min3_u32 v4, v4, v161, v163
    v_max3_u32 v5, v5, v161, v163
    v_min3_u32 v4, v4, v165, v167
    v_mfma_f32_32x32x16_bf16 v[48:63], v[64:67], v[76:79], v[48:63]
    ds_read_b64_tr_b16 v[108:109], v137 offset:61440
    ds_read_b64_tr_b16 v[110:111], v137 offset:61952
    v_max3_u32 v5, v5, v165, v167
    v_min3_u32 v4, v4, v169, v171
    v_max3_u32 v5, v5, v169, v171
    v_cmp_ne_u32 s[14:15], s80, v4
    s_waitcnt lgkmcnt(7)
    v_mfma_f32_32x32x16_bf16 v[16:31], v[84:87], v[80:83], v[16:31]
    ds_read_b128 v[112:115], v135 offset:40960
    ds_read_b64_tr_b16 v[116:117], v137 offset:47104
    ds_read_b64_tr_b16 v[118:119], v137 offset:47616
    v_cmp_ne_u32 s[16:17], s80, v5
    v_cmp_eq_u32 vcc, 0, v3
    s_nop 1
    v_cndmask_b32 v172, 0, v144, vcc
    v_cndmask_b32 v173, 0, v144, vcc
    v_mfma_f32_32x32x16_bf16 v[32:47], v[88:91], v[80:83], v[32:47]
    ds_read_b64_tr_b16 v[120:121], v137 offset:55296
    ds_read_b64_tr_b16 v[122:123], v137 offset:55808
    v_add_f32 v148, v148, v150
    v_add_f32 v152, v152, v154
    v_add_f32 v148, v148, v152
    v_add_f32 v156, v156, v158
    v_mfma_f32_32x32x16_bf16 v[48:63], v[80:83], v[92:95], v[48:63]
    ds_read_b64_tr_b16 v[124:125], v137 offset:63488
    ds_read_b64_tr_b16 v[126:127], v137 offset:64000
    v_add_f32 v160, v160, v162
    v_add_f32 v156, v156, v160
    v_add_f32 v164, v164, v166
    v_add_f32 v168, v168, v170
    s_waitcnt lgkmcnt(7)
    s_barrier
    v_mfma_f32_32x32x16_bf16 v[16:31], v[100:103], v[96:99], v[16:31]
    v_add_f32 v164, v164, v168
    v_mov_b32 v150, v148
    v_mov_b32 v158, v156
    v_mov_b32 v166, v164
    v_permlane32_swap_b32 v150, v148
    v_mfma_f32_32x32x16_bf16 v[32:47], v[104:107], v[96:99], v[32:47]
    v_permlane32_swap_b32 v158, v156
    v_permlane32_swap_b32 v166, v164
    v_add_f32 v148, v150, v148
    v_add_f32 v156, v158, v156
    v_mfma_f32_32x32x16_bf16 v[48:63], v[96:99], v[108:111], v[48:63]
    v_add_f32 v164, v166, v164
    v_cvt_pk_bf16_f32 v176, v148, v148
    v_and_b32 v150, 0xffff0000, v176
    v_sub_f32 v150, v148, v150
    s_waitcnt lgkmcnt(0)
    v_mfma_f32_32x32x16_bf16 v[16:31], v[116:119], v[112:115], v[16:31]
    v_cvt_pk_bf16_f32 v177, v150, v150
    v_cvt_pk_bf16_f32 v180, v156, v156
    v_and_b32 v158, 0xffff0000, v180
    v_sub_f32 v158, v156, v158
    ds_read_b64_tr_b16 v[128:129], v227 offset:0
    ds_read_b64_tr_b16 v[130:131], v227 offset:1024
    ds_read_b64_tr_b16 v[132:133], v228 offset:0
    v_mfma_f32_32x32x16_bf16 v[32:47], v[120:123], v[112:115], v[32:47]
    v_cvt_pk_bf16_f32 v181, v158, v158
    v_cvt_pk_bf16_f32 v184, v164, v164
    v_and_b32 v166, 0xffff0000, v184
    v_sub_f32 v166, v164, v166
    ds_read_b64_tr_b16 v[134:135], v228 offset:1024
    ds_read_b64_tr_b16 v[136:137], v227 offset:2048
    ds_read_b64_tr_b16 v[138:139], v227 offset:3072
    v_mfma_f32_32x32x16_bf16 v[48:63], v[112:115], v[124:127], v[48:63]
    v_cvt_pk_bf16_f32 v185, v166, v166
    ds_read_b64_tr_b16 v[200:201], v228 offset:2048
    ds_read_b64_tr_b16 v[202:203], v228 offset:3072
    s_mov_b32 s73, 0
ST_14:
    s_or_b64 s[14:15], s[14:15], s[16:17]
    s_cbranch_scc0 ST_14d
    s_add_u32 s73, s73, 1
    s_cmp_gt_u32 s73, 20000
    s_cbranch_scc1 ST_14d
    buffer_load_dwordx4 v[144:147], v210, s[36:39], 0 offen sc1
    s_add_u32 s72, s93, 0
    buffer_load_dwordx4 v[148:151], v211, s[36:39], s72 offen offset:0 sc1
    s_add_u32 s72, s93, 0
    buffer_load_dwordx4 v[152:155], v211, s[36:39], s72 offen offset:1024 sc1
    s_add_u32 s72, s93, 4096
    buffer_load_dwordx4 v[156:159], v211, s[36:39], s72 offen offset:0 sc1
    s_add_u32 s72, s93, 4096
    buffer_load_dwordx4 v[160:163], v211, s[36:39], s72 offen offset:1024 sc1
    s_add_u32 s72, s93, 8192
    buffer_load_dwordx4 v[164:167], v211, s[36:39], s72 offen offset:0 sc1
    s_add_u32 s72, s93, 8192
    buffer_load_dwordx4 v[168:171], v211, s[36:39], s72 offen offset:1024 sc1
    s_waitcnt vmcnt(0)
    v_min3_u32 v4, v147, v149, v151
    v_max3_u32 v5, v147, v149, v151
    v_min3_u32 v4, v4, v153, v155
    v_max3_u32 v5, v5, v153, v155
    v_min3_u32 v4, v4, v157, v159
    v_max3_u32 v5, v5, v157, v159
    v_min3_u32 v4, v4, v161, v163
    v_max3_u32 v5, v5, v161, v163
    v_min3_u32 v4, v4, v165, v167
    v_max3_u32 v5, v5, v165, v167
    v_min3_u32 v4, v4, v169, v171
    v_max3_u32 v5, v5, v169, v171
    v_cmp_ne_u32 s[14:15], s80, v4
    v_cmp_ne_u32 s[16:17], s80, v5
    v_cmp_eq_u32 vcc, 0, v3
    s_nop 1
    v_cndmask_b32 v172, 0, v144, vcc
    v_cndmask_b32 v173, 0, v144, vcc
    v_add_f32 v148, v148, v150
    v_add_f32 v152, v152, v154
    v_add_f32 v148, v148, v152
    v_add_f32 v156, v156, v158
    v_add_f32 v160, v160, v162
    v_add_f32 v156, v156, v160
    v_add_f32 v164, v164, v166
    v_add_f32 v168, v168, v170
    v_add_f32 v164, v164, v168
    v_mov_b32 v150, v148
    v_mov_b32 v158, v156
    v_mov_b32 v166, v164
    v_permlane32_swap_b32 v150, v148
    v_permlane32_swap_b32 v158, v156
    v_permlane32_swap_b32 v166, v164
    v_add_f32 v148, v150, v148
    v_add_f32 v156, v158, v156
    v_add_f32 v164, v166, v164
    v_cvt_pk_bf16_f32 v176, v148, v148
    v_and_b32 v150, 0xffff0000, v176
    v_sub_f32 v150, v148, v150
    v_cvt_pk_bf16_f32 v177, v150, v150
    v_cvt_pk_bf16_f32 v180, v156, v156
    v_and_b32 v158, 0xffff0000, v180
    v_sub_f32 v158, v156, v158
    v_cvt_pk_bf16_f32 v181, v158, v158
    v_cvt_pk_bf16_f32 v184, v164, v164
    v_and_b32 v166, 0xffff0000, v184
    v_sub_f32 v166, v164, v166
    v_cvt_pk_bf16_f32 v185, v166, v166
    s_nop 4
    s_branch ST_14
ST_14d:
    v_mfma_f32_32x32x16_bf16 v[32:47], v[180:183], v[172:175], v[32:47]
    v_mfma_f32_32x32x16_bf16 v[48:63], v[172:175], v[184:187], v[48:63]
    v_mfma_f32_32x32x16_bf16 v[16:31], v[176:179], v[172:175], v[16:31]
    ds_write_b32 v219, v145
    v_mov_b32 v10, v146
    ds_read_b128 v[64:67], v220 offset:0
    ds_read_b128 v[68:71], v220 offset:32
    ds_read_b128 v[72:75], v220 offset:64
    ds_read_b128 v[76:79], v220 offset:96
    s_nop 3
    v_cvt_pk_bf16_f32 v96, v32, v33
    v_cvt_pk_bf16_f32 v97, v34, v35
    v_cvt_pk_bf16_f32 v98, v36, v37
    v_cvt_pk_bf16_f32 v99, v38, v39
    v_cvt_pk_bf16_f32 v100, v40, v41
    v_cvt_pk_bf16_f32 v101, v42, v43
    v_cvt_pk_bf16_f32 v102, v44, v45
    v_cvt_pk_bf16_f32 v103, v46, v47
    v_mfma_f32_32x32x16_bf16 v[80:95], v[188:191], v[96:99], 0
    s_nop 0
    v_mfma_f32_32x32x16_bf16 v[80:95], v[192:195], v[100:103], v[80:95]
    s_waitcnt lgkmcnt(0)
    v_pk_mul_f32 v[48:49], v[48:49], v[64:65]
    v_cvt_pk_bf16_f32 v64, v48, v49
    v_pk_mul_f32 v[50:51], v[50:51], v[66:67]
    v_cvt_pk_bf16_f32 v65, v50, v51
    v_pk_mul_f32 v[52:53], v[52:53], v[68:69]
    v_cvt_pk_bf16_f32 v66, v52, v53
    v_pk_mul_f32 v[54:55], v[54:55], v[70:71]
    v_cvt_pk_bf16_f32 v67, v54, v55
    v_pk_mul_f32 v[56:57], v[56:57], v[72:73]
    v_cvt_pk_bf16_f32 v68, v56, v57
    v_pk_mul_f32 v[58:59], v[58:59], v[74:75]
    v_cvt_pk_bf16_f32 v69, v58, v59
    v_pk_mul_f32 v[60:61], v[60:61], v[76:77]
    v_cvt_pk_bf16_f32 v70, v60, v61
    v_pk_mul_f32 v[62:63], v[62:63], v[78:79]
    v_cvt_pk_bf16_f32 v71, v62, v63
    ds_write_b128 v216, v[64:67] offset:0
    ds_write_b128 v216, v[68:71] offset:512
    v_max3_f32 v12, v80, v81, v82
    v_min3_f32 v14, v80, v81, v82
    v_max3_f32 v12, v12, v83, v84
    v_min3_f32 v14, v14, v83, v84
    v_max3_f32 v12, v12, v85, v86
    v_min3_f32 v14, v14, v85, v86
    v_max3_f32 v12, v12, v87, v88
    v_min3_f32 v14, v14, v87, v88
    v_max3_f32 v12, v12, v89, v90
    v_min3_f32 v14, v14, v89, v90
    v_max3_f32 v12, v12, v91, v92
    v_min3_f32 v14, v14, v91, v92
    v_max3_f32 v12, v12, v93, v94
    v_min3_f32 v14, v14, v93, v94
    v_max_f32 v12, v12, v95
    v_min_f32 v14, v14, v95
    v_mul_f32 v12, v12, v10
    v_mul_f32 v14, v14, v10
    v_pk_fma_f32 v[96:97], v[80:81], v[10:11], v[12:13] op_sel_hi:[1,0,0] neg_lo:[0,0,1] neg_hi:[0,0,1]
    v_pk_fma_f32 v[112:113], v[80:81], v[10:11], v[14:15] op_sel_hi:[1,0,0] neg_lo:[1,0,0] neg_hi:[1,0,0]
    v_pk_fma_f32 v[98:99], v[82:83], v[10:11], v[12:13] op_sel_hi:[1,0,0] neg_lo:[0,0,1] neg_hi:[0,0,1]
    v_pk_fma_f32 v[114:115], v[82:83], v[10:11], v[14:15] op_sel_hi:[1,0,0] neg_lo:[1,0,0] neg_hi:[1,0,0]
    v_pk_fma_f32 v[100:101], v[84:85], v[10:11], v[12:13] op_sel_hi:[1,0,0] neg_lo:[0,0,1] neg_hi:[0,0,1]
    v_pk_fma_f32 v[116:117], v[84:85], v[10:11], v[14:15] op_sel_hi:[1,0,0] neg_lo:[1,0,0] neg_hi:[1,0,0]
    v_pk_fma_f32 v[102:103], v[86:87], v[10:11], v[12:13] op_sel_hi:[1,0,0] neg_lo:[0,0,1] neg_hi:[0,0,1]
    v_pk_fma_f32 v[118:119], v[86:87], v[10:11], v[14:15] op_sel_hi:[1,0,0] neg_lo:[1,0,0] neg_hi:[1,0,0]
    v_pk_fma_f32 v[104:105], v[88:89], v[10:11], v[12:13] op_sel_hi:[1,0,0] neg_lo:[0,0,1] neg_hi:[0,0,1]
    v_pk_fma_f32 v[120:121], v[88:89], v[10:11], v[14:15] op_sel_hi:[1,0,0] neg_lo:[1,0,0] neg_hi:[1,0,0]
    v_pk_fma_f32 v[106:107], v[90:91], v[10:11], v[12:13] op_sel_hi:[1,0,0] neg_lo:[0,0,1] neg_hi:[0,0,1]
    v_pk_fma_f32 v[122:123], v[90:91], v[10:11], v[14:15] op_sel_hi:[1,0,0] neg_lo:[1,0,0] neg_hi:[1,0,0]
    v_pk_fma_f32 v[108:109], v[92:93], v[10:11], v[12:13] op_sel_hi:[1,0,0] neg_lo:[0,0,1] neg_hi:[0,0,1]
    v_pk_fma_f32 v[124:125], v[92:93], v[10:11], v[14:15] op_sel_hi:[1,0,0] neg_lo:[1,0,0] neg_hi:[1,0,0]
    v_pk_fma_f32 v[110:111], v[94:95], v[10:11], v[12:13] op_sel_hi:[1,0,0] neg_lo:[0,0,1] neg_hi:[0,0,1]
    v_pk_fma_f32 v[126:127], v[94:95], v[10:11], v[14:15] op_sel_hi:[1,0,0] neg_lo:[1,0,0] neg_hi:[1,0,0]
    v_exp_f32 v96, v96
    v_exp_f32 v97, v97
    v_exp_f32 v98, v98
    v_exp_f32 v99, v99
    v_exp_f32 v100, v100
    v_exp_f32 v101, v101
    v_exp_f32 v102, v102
    v_exp_f32 v103, v103
    v_exp_f32 v104, v104
    v_exp_f32 v105, v105
    v_exp_f32 v106, v106
    v_exp_f32 v107, v107
    v_exp_f32 v108, v108
    v_exp_f32 v109, v109
    v_exp_f32 v110, v110
    v_exp_f32 v111, v111
    v_exp_f32 v112, v112
    v_exp_f32 v113, v113
    v_exp_f32 v114, v114
    v_exp_f32 v115, v115
    v_exp_f32 v116, v116
    v_exp_f32 v117, v117
    v_exp_f32 v118, v118
    v_exp_f32 v119, v119
    v_exp_f32 v120, v120
    v_exp_f32 v121, v121
    v_exp_f32 v122, v122
    v_exp_f32 v123, v123
    v_exp_f32 v124, v124
    v_exp_f32 v125, v125
    v_exp_f32 v126, v126
    v_exp_f32 v127, v127
    v_pk_add_f32 v[12:13], v[96:97], v[98:99]
    v_pk_add_f32 v[14:15], v[112:113], v[114:115]
    v_pk_add_f32 v[12:13], v[12:13], v[100:101]
    v_pk_add_f32 v[14:15], v[14:15], v[116:117]
    v_pk_add_f32 v[12:13], v[12:13], v[102:103]
    v_pk_add_f32 v[14:15], v[14:15], v[118:119]
    v_pk_add_f32 v[12:13], v[12:13], v[104:105]
    v_pk_add_f32 v[14:15], v[14:15], v[120:121]
    v_pk_add_f32 v[12:13], v[12:13], v[106:107]
    v_pk_add_f32 v[14:15], v[14:15], v[122:123]
    v_pk_add_f32 v[12:13], v[12:13], v[108:109]
    v_pk_add_f32 v[14:15], v[14:15], v[124:125]
    v_pk_add_f32 v[12:13], v[12:13], v[110:111]
    v_pk_add_f32 v[14:15], v[14:15], v[126:127]
    v_add_f32 v12, v12, v13
    v_add_f32 v14, v14, v15
    v_rcp_f32 v12, v12
    v_rcp_f32 v14, v14
    v_pk_mul_f32 v[96:97], v[96:97], v[12:13] op_sel_hi:[1,0]
    v_cvt_pk_bf16_f32 v148, v96, v97
    v_pk_mul_f32 v[98:99], v[98:99], v[12:13] op_sel_hi:[1,0]
    v_cvt_pk_bf16_f32 v149, v98, v99
    v_pk_mul_f32 v[100:101], v[100:101], v[12:13] op_sel_hi:[1,0]
    v_cvt_pk_bf16_f32 v150, v100, v101
    v_pk_mul_f32 v[102:103], v[102:103], v[12:13] op_sel_hi:[1,0]
    v_cvt_pk_bf16_f32 v151, v102, v103
    ds_write_b128 v212, v[148:151]
    v_pk_mul_f32 v[104:105], v[104:105], v[12:13] op_sel_hi:[1,0]
    v_cvt_pk_bf16_f32 v152, v104, v105
    v_pk_mul_f32 v[106:107], v[106:107], v[12:13] op_sel_hi:[1,0]
    v_cvt_pk_bf16_f32 v153, v106, v107
    v_pk_mul_f32 v[108:109], v[108:109], v[12:13] op_sel_hi:[1,0]
    v_cvt_pk_bf16_f32 v154, v108, v109
    v_pk_mul_f32 v[110:111], v[110:111], v[12:13] op_sel_hi:[1,0]
    v_cvt_pk_bf16_f32 v155, v110, v111
    ds_write_b128 v213, v[152:155]
    v_pk_mul_f32 v[112:113], v[112:113], v[14:15] op_sel_hi:[1,0]
    v_cvt_pk_bf16_f32 v156, v112, v113
    v_pk_mul_f32 v[114:115], v[114:115], v[14:15] op_sel_hi:[1,0]
    v_cvt_pk_bf16_f32 v157, v114, v115
    v_pk_mul_f32 v[116:117], v[116:117], v[14:15] op_sel_hi:[1,0]
    v_cvt_pk_bf16_f32 v158, v116, v117
    v_pk_mul_f32 v[118:119], v[118:119], v[14:15] op_sel_hi:[1,0]
    v_cvt_pk_bf16_f32 v159, v118, v119
    ds_write_b128 v214, v[156:159]
    v_pk_mul_f32 v[120:121], v[120:121], v[14:15] op_sel_hi:[1,0]
    v_cvt_pk_bf16_f32 v160, v120, v121
    v_pk_mul_f32 v[122:123], v[122:123], v[14:15] op_sel_hi:[1,0]
    v_cvt_pk_bf16_f32 v161, v122, v123
    v_pk_mul_f32 v[124:125], v[124:125], v[14:15] op_sel_hi:[1,0]
    v_cvt_pk_bf16_f32 v162, v124, v125
    v_pk_mul_f32 v[126:127], v[126:127], v[14:15] op_sel_hi:[1,0]
    v_cvt_pk_bf16_f32 v163, v126, v127
    ds_write_b128 v215, v[160:163]
    v_mov_b32 v164, s90
    v_mov_b32 v165, s90
    v_mov_b32 v166, s90
    v_mov_b32 v167, s90
    v_cvt_pk_bf16_f32 v96, v16, v17
    v_cvt_pk_bf16_f32 v97, v18, v19
    v_cvt_pk_bf16_f32 v98, v20, v21
    v_cvt_pk_bf16_f32 v99, v22, v23
    v_cvt_pk_bf16_f32 v100, v24, v25
    v_cvt_pk_bf16_f32 v101, v26, v27
    v_cvt_pk_bf16_f32 v102, v28, v29
    v_cvt_pk_bf16_f32 v103, v30, v31
    v_mfma_f32_32x32x16_bf16 v[80:95], v[188:191], v[96:99], 0
    s_nop 0
    v_mfma_f32_32x32x16_bf16 v[80:95], v[192:195], v[100:103], v[80:95]
    s_waitcnt lgkmcnt(0)
    s_barrier
    ds_read_b64_tr_b16 v[32:33], v217 offset:0
    ds_read_b64_tr_b16 v[34:35], v217 offset:512
    ds_read_b128 v[48:51], v218 offset:0
    ds_read_b64_tr_b16 v[36:37], v217 offset:4096
    ds_read_b64_tr_b16 v[38:39], v217 offset:4608
    ds_read_b128 v[52:55], v218 offset:2048
    ds_read_b64_tr_b16 v[40:41], v217 offset:8192
    ds_read_b64_tr_b16 v[42:43], v217 offset:8704
    ds_read_b128 v[56:59], v218 offset:4096
    ds_read_b64_tr_b16 v[44:45], v217 offset:12288
    ds_read_b64_tr_b16 v[46:47], v217 offset:12800
    ds_read_b128 v[60:63], v218 offset:6144
    s_waitcnt lgkmcnt(9)
    v_mfma_f32_16x16x32_bf16 v[64:67], v[32:35], v[48:51], 0
    v_mfma_f32_16x16x32_bf16 v[68:71], v[32:35], v[164:167], 0
    s_waitcnt lgkmcnt(6)
    v_mfma_f32_16x16x32_bf16 v[64:67], v[36:39], v[52:55], v[64:67]
    v_mfma_f32_16x16x32_bf16 v[68:71], v[36:39], v[164:167], v[68:71]
    s_waitcnt lgkmcnt(3)
    v_mfma_f32_16x16x32_bf16 v[64:67], v[40:43], v[56:59], v[64:67]
    v_mfma_f32_16x16x32_bf16 v[68:71], v[40:43], v[164:167], v[68:71]
    s_waitcnt lgkmcnt(0)
    v_mfma_f32_16x16x32_bf16 v[64:67], v[44:47], v[60:63], v[64:67]
    v_mfma_f32_16x16x32_bf16 v[68:71], v[44:47], v[164:167], v[68:71]
    s_nop 6
    v_cvt_pk_bf16_f32 v72, v64, v65
    v_cvt_pk_bf16_f32 v73, v66, v67
    v_cvt_pk_bf16_f32 v76, v68, v69
    v_cvt_pk_bf16_f32 v77, v70, v71
    v_mov_b32_dpp v74, v72 quad_perm:[1,0,3,2] row_mask:0xf bank_mask:0xf
    v_mov_b32_dpp v75, v73 quad_perm:[1,0,3,2] row_mask:0xf bank_mask:0xf
    buffer_store_dwordx4 v[72:75], v225, s[36:39], s8 offen sc1
    buffer_store_dwordx2 v[76:77], v221, s[36:39], s13 offen sc1
    s_mov_b32 s72, 524288
    s_add_u32 m0, s76, 131072
    s_nop 0
    buffer_load_dwordx4 v142, s[44:47], s72 offen lds
    v_max3_f32 v12, v80, v81, v82
    v_min3_f32 v14, v80, v81, v82
    v_max3_f32 v12, v12, v83, v84
    v_min3_f32 v14, v14, v83, v84
    v_max3_f32 v12, v12, v85, v86
    v_min3_f32 v14, v14, v85, v86
    v_max3_f32 v12, v12, v87, v88
    v_min3_f32 v14, v14, v87, v88
    v_max3_f32 v12, v12, v89, v90
    v_min3_f32 v14, v14, v89, v90
    v_max3_f32 v12, v12, v91, v92
    v_min3_f32 v14, v14, v91, v92
    v_max3_f32 v12, v12, v93, v94
    v_min3_f32 v14, v14, v93, v94
    v_max_f32 v12, v12, v95
    v_min_f32 v14, v14, v95
    v_mul_f32 v12, v12, v10
    v_mul_f32 v14, v14, v10
    v_pk_fma_f32 v[96:97], v[80:81], v[10:11], v[12:13] op_sel_hi:[1,0,0] neg_lo:[0,0,1] neg_hi:[0,0,1]
    v_pk_fma_f32 v[112:113], v[80:81], v[10:11], v[14:15] op_sel_hi:[1,0,0] neg_lo:[1,0,0] neg_hi:[1,0,0]
    s_mov_b32 s72, 524288
    s_add_u32 m0, s76, 132096
    s_nop 0
    buffer_load_dwordx4 v143, s[44:47], s72 offen lds
    v_pk_fma_f32 v[98:99], v[82:83], v[10:11], v[12:13] op_sel_hi:[1,0,0] neg_lo:[0,0,1] neg_hi:[0,0,1]
    v_pk_fma_f32 v[114:115], v[82:83], v[10:11], v[14:15] op_sel_hi:[1,0,0] neg_lo:[1,0,0] neg_hi:[1,0,0]
    v_pk_fma_f32 v[100:101], v[84:85], v[10:11], v[12:13] op_sel_hi:[1,0,0] neg_lo:[0,0,1] neg_hi:[0,0,1]
    v_pk_fma_f32 v[116:117], v[84:85], v[10:11], v[14:15] op_sel_hi:[1,0,0] neg_lo:[1,0,0] neg_hi:[1,0,0]
    v_pk_fma_f32 v[102:103], v[86:87], v[10:11], v[12:13] op_sel_hi:[1,0,0] neg_lo:[0,0,1] neg_hi:[0,0,1]
    v_pk_fma_f32 v[118:119], v[86:87], v[10:11], v[14:15] op_sel_hi:[1,0,0] neg_lo:[1,0,0] neg_hi:[1,0,0]
    v_pk_fma_f32 v[104:105], v[88:89], v[10:11], v[12:13] op_sel_hi:[1,0,0] neg_lo:[0,0,1] neg_hi:[0,0,1]
    v_pk_fma_f32 v[120:121], v[88:89], v[10:11], v[14:15] op_sel_hi:[1,0,0] neg_lo:[1,0,0] neg_hi:[1,0,0]
    v_pk_fma_f32 v[106:107], v[90:91], v[10:11], v[12:13] op_sel_hi:[1,0,0] neg_lo:[0,0,1] neg_hi:[0,0,1]
    v_pk_fma_f32 v[122:123], v[90:91], v[10:11], v[14:15] op_sel_hi:[1,0,0] neg_lo:[1,0,0] neg_hi:[1,0,0]
    v_pk_fma_f32 v[108:109], v[92:93], v[10:11], v[12:13] op_sel_hi:[1,0,0] neg_lo:[0,0,1] neg_hi:[0,0,1]
    v_pk_fma_f32 v[124:125], v[92:93], v[10:11], v[14:15] op_sel_hi:[1,0,0] neg_lo:[1,0,0] neg_hi:[1,0,0]
    v_pk_fma_f32 v[110:111], v[94:95], v[10:11], v[12:13] op_sel_hi:[1,0,0] neg_lo:[0,0,1] neg_hi:[0,0,1]
    v_pk_fma_f32 v[126:127], v[94:95], v[10:11], v[14:15] op_sel_hi:[1,0,0] neg_lo:[1,0,0] neg_hi:[1,0,0]
    v_exp_f32 v96, v96
    s_mov_b32 s72, 655360
    s_add_u32 m0, s76, 147456
    s_nop 0
    buffer_load_dwordx4 v142, s[44:47], s72 offen lds
    v_exp_f32 v97, v97
    v_exp_f32 v98, v98
    v_exp_f32 v99, v99
    v_exp_f32 v100, v100
    v_exp_f32 v101, v101
    v_exp_f32 v102, v102
    s_mov_b32 s72, 655360
    s_add_u32 m0, s76, 148480
    s_nop 0
    buffer_load_dwordx4 v143, s[44:47], s72 offen lds
    v_exp_f32 v103, v103
    v_exp_f32 v104, v104
    v_exp_f32 v105, v105
    v_exp_f32 v106, v106
    v_exp_f32 v107, v107
    v_exp_f32 v108, v108
    s_mov_b32 s72, 1179648
    s_add_u32 m0, s76, 0
    s_nop 0
    buffer_load_dwordx4 v142, s[44:47], s72 offen lds
    v_exp_f32 v109, v109
    v_exp_f32 v110, v110
    v_exp_f32 v111, v111
    v_exp_f32 v112, v112
    v_exp_f32 v113, v113
    v_exp_f32 v114, v114
    s_mov_b32 s72, 1179648
    s_add_u32 m0, s76, 1024
    s_nop 0
    buffer_load_dwordx4 v143, s[44:47], s72 offen lds
    v_exp_f32 v115, v115
    v_exp_f32 v116, v116
    v_exp_f32 v117, v117
    v_exp_f32 v118, v118
    v_exp_f32 v119, v119
    v_exp_f32 v120, v120
    s_cmp_ge_u32 s64, 6
    s_mov_b32 s72, 1310720
    s_cmov_b32 s72, 1277952
    s_mov_b32 s73, 118784
    s_cmov_b32 s73, 114688
    s_add_u32 m0, s76, s73
    s_nop 0
    buffer_load_dwordx4 v142, s[44:47], s72 offen lds
    v_exp_f32 v121, v121
    v_exp_f32 v122, v122
    v_exp_f32 v123, v123
    v_exp_f32 v124, v124
    v_exp_f32 v125, v125
    v_exp_f32 v126, v126
    s_cmp_ge_u32 s64, 6
    s_mov_b32 s72, 1310720
    s_cmov_b32 s72, 1277952
    s_mov_b32 s73, 119808
    s_cmov_b32 s73, 115712
    s_add_u32 m0, s76, s73
    s_nop 0
    buffer_load_dwordx4 v143, s[44:47], s72 offen lds
    v_exp_f32 v127, v127
    v_pk_add_f32 v[12:13], v[96:97], v[98:99]
    v_pk_add_f32 v[14:15], v[112:113], v[114:115]
    v_pk_add_f32 v[12:13], v[12:13], v[100:101]
    v_pk_add_f32 v[14:15], v[14:15], v[116:117]
    v_pk_add_f32 v[12:13], v[12:13], v[102:103]
    v_pk_add_f32 v[14:15], v[14:15], v[118:119]
    v_pk_add_f32 v[12:13], v[12:13], v[104:105]
    v_pk_add_f32 v[14:15], v[14:15], v[120:121]
    v_pk_add_f32 v[12:13], v[12:13], v[106:107]
    v_pk_add_f32 v[14:15], v[14:15], v[122:123]
    v_pk_add_f32 v[12:13], v[12:13], v[108:109]
    v_pk_add_f32 v[14:15], v[14:15], v[124:125]
    v_pk_add_f32 v[12:13], v[12:13], v[110:111]
    v_pk_add_f32 v[14:15], v[14:15], v[126:127]
    v_add_f32 v12, v12, v13
    v_add_f32 v14, v14, v15
    v_rcp_f32 v12, v12
    v_rcp_f32 v14, v14
    v_pk_mul_f32 v[96:97], v[96:97], v[12:13] op_sel_hi:[1,0]
    v_cvt_pk_bf16_f32 v148, v96, v97
    v_pk_mul_f32 v[98:99], v[98:99], v[12:13] op_sel_hi:[1,0]
    v_cvt_pk_bf16_f32 v149, v98, v99
    v_pk_mul_f32 v[100:101], v[100:101], v[12:13] op_sel_hi:[1,0]
    v_cvt_pk_bf16_f32 v150, v100, v101
    v_pk_mul_f32 v[102:103], v[102:103], v[12:13] op_sel_hi:[1,0]
    v_cvt_pk_bf16_f32 v151, v102, v103
    v_pk_mul_f32 v[104:105], v[104:105], v[12:13] op_sel_hi:[1,0]
    v_cvt_pk_bf16_f32 v152, v104, v105
    v_pk_mul_f32 v[106:107], v[106:107], v[12:13] op_sel_hi:[1,0]
    v_cvt_pk_bf16_f32 v153, v106, v107
    v_pk_mul_f32 v[108:109], v[108:109], v[12:13] op_sel_hi:[1,0]
    v_cvt_pk_bf16_f32 v154, v108, v109
    v_pk_mul_f32 v[110:111], v[110:111], v[12:13] op_sel_hi:[1,0]
    v_cvt_pk_bf16_f32 v155, v110, v111
    v_pk_mul_f32 v[112:113], v[112:113], v[14:15] op_sel_hi:[1,0]
    v_cvt_pk_bf16_f32 v156, v112, v113
    v_pk_mul_f32 v[114:115], v[114:115], v[14:15] op_sel_hi:[1,0]
    v_cvt_pk_bf16_f32 v157, v114, v115
    v_pk_mul_f32 v[116:117], v[116:117], v[14:15] op_sel_hi:[1,0]
    v_cvt_pk_bf16_f32 v158, v116, v117
    v_pk_mul_f32 v[118:119], v[118:119], v[14:15] op_sel_hi:[1,0]
    v_cvt_pk_bf16_f32 v159, v118, v119
    v_pk_mul_f32 v[120:121], v[120:121], v[14:15] op_sel_hi:[1,0]
    v_cvt_pk_bf16_f32 v160, v120, v121
    v_pk_mul_f32 v[122:123], v[122:123], v[14:15] op_sel_hi:[1,0]
    v_cvt_pk_bf16_f32 v161, v122, v123
    v_pk_mul_f32 v[124:125], v[124:125], v[14:15] op_sel_hi:[1,0]
    v_cvt_pk_bf16_f32 v162, v124, v125
    v_pk_mul_f32 v[126:127], v[126:127], v[14:15] op_sel_hi:[1,0]
    v_cvt_pk_bf16_f32 v163, v126, v127
    s_waitcnt vmcnt(8)
    s_barrier
    s_cmp_eq_u32 s64, 0
    s_cselect_b32 s72, s4, 1073741824
    v_mov_b32 v14, s80
    buffer_store_dword v14, v198, s[36:39], s72 offen sc1
    s_mov_b32 s72, 786432
    s_add_u32 m0, s76, 65536
    s_nop 0
    buffer_load_dwordx4 v142, s[44:47], s72 offen lds
    s_mov_b32 s72, 786432
    s_add_u32 m0, s76, 66560
    s_nop 0
    buffer_load_dwordx4 v143, s[44:47], s72 offen lds
    s_mov_b32 s72, 917504
    s_add_u32 m0, s76, 81920
    s_nop 0
    buffer_load_dwordx4 v142, s[44:47], s72 offen lds
    s_mov_b32 s72, 917504
    s_add_u32 m0, s76, 82944
    s_nop 0
    buffer_load_dwordx4 v143, s[44:47], s72 offen lds
    s_mov_b32 s72, 1048576
    s_add_u32 m0, s76, 98304
    s_nop 0
    buffer_load_dwordx4 v142, s[44:47], s72 offen lds
    s_mov_b32 s72, 1048576
    s_add_u32 m0, s76, 99328
    s_nop 0
    buffer_load_dwordx4 v143, s[44:47], s72 offen lds
    s_cmp_lg_u32 s64, 0
    s_cbranch_scc1 PL_15d
    s_mov_b64 exec, 16711680
    s_mov_b32 s73, 0
    s_mov_b32 s72, 0
PL_15:
    buffer_load_dword v15, v197, s[36:39], s72 offen sc1
    s_waitcnt vmcnt(0)
    v_cmp_ne_u32 vcc, s80, v15
    s_add_u32 s73, s73, 1
    s_cmp_gt_u32 s73, 20000
    s_cbranch_scc1 PL_15x
    s_cbranch_vccnz PL_15
PL_15x:
    s_mov_b64 exec, -1
PL_15d:
    s_barrier
    s_add_u32 s72, s11, 0
    buffer_load_dwordx4 v[56:59], v226, s[36:39], s72 offen offset:0 sc1
    s_add_u32 s72, s11, 0
    buffer_load_dwordx4 v[60:63], v226, s[36:39], s72 offen offset:1024 sc1
    s_add_u32 s72, s11, 8192
    buffer_load_dwordx4 v[96:99], v226, s[36:39], s72 offen offset:0 sc1
    s_add_u32 s72, s11, 8192
    buffer_load_dwordx4 v[100:103], v226, s[36:39], s72 offen offset:1024 sc1
    s_add_u32 s72, s11, 16384
    buffer_load_dwordx4 v[104:107], v226, s[36:39], s72 offen offset:0 sc1
    s_add_u32 s72, s11, 16384
    buffer_load_dwordx4 v[108:111], v226, s[36:39], s72 offen offset:1024 sc1
    s_cmp_lg_u32 s64, 0
    s_cbranch_scc1 PL_16d
    s_mov_b64 exec, 65535
    s_mov_b32 s73, 0
    s_mov_b32 s72, 0
PL_16:
    buffer_load_dword v15, v197, s[36:39], s72 offen sc1
    s_waitcnt vmcnt(0)
    v_cmp_ne_u32 vcc, s80, v15
    s_add_u32 s73, s73, 1
    s_cmp_gt_u32 s73, 20000
    s_cbranch_scc1 PL_16x
    s_cbranch_vccnz PL_16
PL_16x:
    s_mov_b64 exec, -1
PL_16d:
    s_barrier
    s_add_u32 s72, s9, 0
    buffer_load_dwordx4 v[176:179], v196, s[36:39], s72 offen sc1
    s_add_u32 s72, s9, 4608
    buffer_load_dwordx4 v[180:183], v196, s[36:39], s72 offen sc1
    s_add_u32 s72, s9, 9216
    buffer_load_dwordx4 v[184:187], v196, s[36:39], s72 offen sc1
    s_add_u32 s72, s9, 13824
    buffer_load_dwordx4 v[188:191], v196, s[36:39], s72 offen sc1
    s_add_u32 s72, s9, 18432
    buffer_load_dwordx4 v[192:195], v196, s[36:39], s72 offen sc1
    s_add_u32 s72, s9, 23040
    buffer_load_dwordx4 v[204:207], v196, s[36:39], s72 offen sc1
    s_add_u32 s72, s9, 27648
    buffer_load_dwordx4 v[208:211], v196, s[36:39], s72 offen sc1
    s_add_u32 s72, s9, 32256
    buffer_load_dwordx4 v[212:215], v196, s[36:39], s72 offen sc1
    buffer_load_dwordx4 v[144:147], v224, s[36:39], s13 offen offset:0 sc1
    buffer_load_dwordx4 v[164:167], v224, s[36:39], s13 offen offset:256 sc1
    buffer_load_dwordx4 v[168:171], v224, s[36:39], s13 offen offset:512 sc1
    buffer_load_dwordx4 v[172:175], v224, s[36:39], s13 offen offset:768 sc1
    s_add_u32 s72, s11, 24576
    buffer_load_dwordx4 v[112:115], v226, s[36:39], s72 offen offset:0 sc1
    s_add_u32 s72, s11, 24576
    buffer_load_dwordx4 v[116:119], v226, s[36:39], s72 offen offset:1024 sc1
    s_add_u32 s72, s11, 32768
    buffer_load_dwordx4 v[120:123], v226, s[36:39], s72 offen offset:0 sc1
    s_add_u32 s72, s11, 32768
    buffer_load_dwordx4 v[124:127], v226, s[36:39], s72 offen offset:1024 sc1
    s_waitcnt vmcnt(20) lgkmcnt(0)
    v_mfma_f32_32x32x16_bf16 v[16:31], v[128:131], v[56:59], 0
    ds_read_b64_tr_b16 v[64:65], v227 offset:16384
    ds_read_b64_tr_b16 v[66:67], v227 offset:17408
    v_mfma_f32_32x32x16_bf16 v[32:47], v[132:135], v[56:59], 0
    ds_read_b64_tr_b16 v[68:69], v228 offset:16384
    ds_read_b64_tr_b16 v[70:71], v228 offset:17408
    v_mfma_f32_32x32x16_bf16 v[16:31], v[136:139], v[60:63], v[16:31]
    ds_read_b64_tr_b16 v[72:73], v227 offset:18432
    ds_read_b64_tr_b16 v[74:75], v227 offset:19456
    v_mfma_f32_32x32x16_bf16 v[32:47], v[200:203], v[60:63], v[32:47]
    ds_read_b64_tr_b16 v[76:77], v228 offset:18432
    ds_read_b64_tr_b16 v[78:79], v228 offset:19456
    s_waitcnt vmcnt(18) lgkmcnt(0)
    v_mfma_f32_32x32x16_bf16 v[16:31], v[64:67], v[96:99], v[16:31]
    ds_read_b64_tr_b16 v[128:129], v227 offset:32768
    ds_read_b64_tr_b16 v[130:131], v227 offset:33792
    v_mfma_f32_32x32x16_bf16 v[32:47], v[68:71], v[96:99], v[32:47]
    ds_read_b64_tr_b16 v[132:133], v228 offset:32768
    ds_read_b64_tr_b16 v[134:135], v228 offset:33792
    v_mfma_f32_32x32x16_bf16 v[16:31], v[72:75], v[100:103], v[16:31]
    ds_read_b64_tr_b16 v[136:137], v227 offset:34816
    ds_read_b64_tr_b16 v[138:139], v227 offset:35840
    v_mfma_f32_32x32x16_bf16 v[32:47], v[76:79], v[100:103], v[32:47]
    ds_read_b64_tr_b16 v[200:201], v228 offset:34816
    ds_read_b64_tr_b16 v[202:203], v228 offset:35840
    s_waitcnt vmcnt(16) lgkmcnt(0)
    v_mfma_f32_32x32x16_bf16 v[16:31], v[128:131], v[104:107], v[16:31]
    ds_read_b64_tr_b16 v[64:65], v227 offset:49152
    ds_read_b64_tr_b16 v[66:67], v227 offset:50176
    v_mfma_f32_32x32x16_bf16 v[32:47], v[132:135], v[104:107], v[32:47]
    ds_read_b64_tr_b16 v[68:69], v228 offset:49152
    ds_read_b64_tr_b16 v[70:71], v228 offset:50176
    v_mfma_f32_32x32x16_bf16 v[16:31], v[136:139], v[108:111], v[16:31]
    ds_read_b64_tr_b16 v[72:73], v227 offset:51200
    ds_read_b64_tr_b16 v[74:75], v227 offset:52224
    v_mfma_f32_32x32x16_bf16 v[32:47], v[200:203], v[108:111], v[32:47]
    ds_read_b64_tr_b16 v[76:77], v228 offset:51200
    ds_read_b64_tr_b16 v[78:79], v228 offset:52224
    s_waitcnt vmcnt(15)
    v_dot2_f32_bf16 v48, v176, s91, 0
    v_dot2_f32_bf16 v49, v176, s92, 0
    v_dot2_f32_bf16 v50, v177, s91, 0
    v_dot2_f32_bf16 v51, v177, s92, 0
    v_dot2_f32_bf16 v52, v178, s91, 0
    v_dot2_f32_bf16 v53, v178, s92, 0
    v_dot2_f32_bf16 v54, v179, s91, 0
    v_dot2_f32_bf16 v55, v179, s92, 0
    s_waitcnt vmcnt(14)
    v_dot2_f32_bf16 v48, v180, s91, v48
    v_dot2_f32_bf16 v49, v180, s92, v49
    v_dot2_f32_bf16 v50, v181, s91, v50
    v_dot2_f32_bf16 v51, v181, s92, v51
    v_dot2_f32_bf16 v52, v182, s91, v52
    v_dot2_f32_bf16 v53, v182, s92, v53
    v_dot2_f32_bf16 v54, v183, s91, v54
    v_dot2_f32_bf16 v55, v183, s92, v55
    s_waitcnt vmcnt(13)
    v_dot2_f32_bf16 v48, v184, s91, v48
    v_dot2_f32_bf16 v49, v184, s92, v49
    v_dot2_f32_bf16 v50, v185, s91, v50
    v_dot2_f32_bf16 v51, v185, s92, v51
    v_dot2_f32_bf16 v52, v186, s91, v52
    v_dot2_f32_bf16 v53, v186, s92, v53
    v_dot2_f32_bf16 v54, v187, s91, v54
    v_dot2_f32_bf16 v55, v187, s92, v55
    s_waitcnt vmcnt(12)
    v_dot2_f32_bf16 v48, v188, s91, v48
    v_dot2_f32_bf16 v49, v188, s92, v49
    v_dot2_f32_bf16 v50, v189, s91, v50
    v_dot2_f32_bf16 v51, v189, s92, v51
    v_dot2_f32_bf16 v52, v190, s91, v52
    v_dot2_f32_bf16 v53, v190, s92, v53
    v_dot2_f32_bf16 v54, v191, s91, v54
    v_dot2_f32_bf16 v55, v191, s92, v55
    s_waitcnt vmcnt(11)
    v_dot2_f32_bf16 v48, v192, s91, v48
    v_dot2_f32_bf16 v49, v192, s92, v49
    v_dot2_f32_bf16 v50, v193, s91, v50
    v_dot2_f32_bf16 v51, v193, s92, v51
    v_dot2_f32_bf16 v52, v194, s91, v52
    v_dot2_f32_bf16 v53, v194, s92, v53
    v_dot2_f32_bf16 v54, v195, s91, v54
    v_dot2_f32_bf16 v55, v195, s92, v55
    s_waitcnt vmcnt(10)
    v_dot2_f32_bf16 v48, v204, s91, v48
    v_dot2_f32_bf16 v49, v204, s92, v49
    v_dot2_f32_bf16 v50, v205, s91, v50
    v_dot2_f32_bf16 v51, v205, s92, v51
    v_dot2_f32_bf16 v52, v206, s91, v52
    v_dot2_f32_bf16 v53, v206, s92, v53
    v_dot2_f32_bf16 v54, v207, s91, v54
    v_dot2_f32_bf16 v55, v207, s92, v55
    s_waitcnt vmcnt(9)
    v_dot2_f32_bf16 v48, v208, s91, v48
    v_dot2_f32_bf16 v49, v208, s92, v49
    v_dot2_f32_bf16 v50, v209, s91, v50
    v_dot2_f32_bf16 v51, v209, s92, v51
    v_dot2_f32_bf16 v52, v210, s91, v52
    v_dot2_f32_bf16 v53, v210, s92, v53
    v_dot2_f32_bf16 v54, v211, s91, v54
    v_dot2_f32_bf16 v55, v211, s92, v55
    s_waitcnt vmcnt(8)
    v_dot2_f32_bf16 v48, v212, s91, v48
    v_dot2_f32_bf16 v49, v212, s92, v49
    v_dot2_f32_bf16 v50, v213, s91, v50
    v_dot2_f32_bf16 v51, v213, s92, v51
    v_dot2_f32_bf16 v52, v214, s91, v52
    v_dot2_f32_bf16 v53, v214, s92, v53
    v_dot2_f32_bf16 v54, v215, s91, v54
    v_dot2_f32_bf16 v55, v215, s92, v55
    v_permlane32_swap_b32 v48, v52
    v_permlane32_swap_b32 v49, v53
    v_permlane32_swap_b32 v50, v54
    v_permlane32_swap_b32 v51, v55
    v_pk_add_f32 v[48:49], v[48:49], v[52:53]
    v_pk_add_f32 v[50:51], v[50:51], v[54:55]
    v_cvt_pk_bf16_f32 v52, v48, v49
    v_cvt_pk_bf16_f32 v53, v50, v51
    ds_write_b64 v222, v[52:53]
    s_waitcnt vmcnt(4)
    v_mfma_f32_32x32x16_bf16 v[80:95], v[144:147], v[148:151], 0
    v_mfma_f32_32x32x16_bf16 v[80:95], v[164:167], v[152:155], v[80:95]
    v_mfma_f32_32x32x16_bf16 v[80:95], v[168:171], v[156:159], v[80:95]
    v_mfma_f32_32x32x16_bf16 v[80:95], v[172:175], v[160:163], v[80:95]
    v_pk_mul_f32 v[176:177], 0, 0
    v_pk_mul_f32 v[178:179], 0, 0
    v_pk_mul_f32 v[180:181], 0, 0
    v_pk_mul_f32 v[182:183], 0, 0
    v_pk_mul_f32 v[184:185], 0, 0
    v_pk_mul_f32 v[186:187], 0, 0
    v_pk_mul_f32 v[188:189], 0, 0
    v_pk_mul_f32 v[190:191], 0, 0
    s_add_u32 s72, s11, 40960
    buffer_load_dwordx4 v[144:147], v226, s[36:39], s72 offen offset:0 sc1
    s_add_u32 s72, s11, 40960
    buffer_load_dwordx4 v[164:167], v226, s[36:39], s72 offen offset:1024 sc1
    s_waitcnt lgkmcnt(0)
    s_barrier
    s_mov_b64 exec, s[20:21]
    ds_read_b128 v[176:179], v223 offset:0
    ds_read_b128 v[180:183], v223 offset:16
    ds_read_b128 v[184:187], v223 offset:32
    ds_read_b128 v[188:191], v223 offset:48
    s_mov_b64 exec, -1
    s_add_u32 s72, s11, 49152
    buffer_load_dwordx4 v[168:171], v226, s[36:39], s72 offen offset:0 sc1
    s_add_u32 s72, s11, 49152
    buffer_load_dwordx4 v[172:175], v226, s[36:39], s72 offen offset:1024 sc1
    v_pk_add_f32 v[80:81], v[80:81], v[88:89]
    v_pk_add_f32 v[82:83], v[82:83], v[90:91]
    v_pk_add_f32 v[84:85], v[84:85], v[92:93]
    v_pk_add_f32 v[86:87], v[86:87], v[94:95]
    v_pk_add_f32 v[80:81], v[80:81], v[84:85]
    v_pk_add_f32 v[82:83], v[82:83], v[86:87]
    v_pk_add_f32 v[80:81], v[80:81], v[82:83]
    v_add_f32 v12, v80, v81
    v_add_f32 v12, 0x358637bd, v12
    v_rcp_f32 v12, v12
    s_waitcnt lgkmcnt(3)
    v_mfma_f32_32x32x16_bf16 v[80:95], v[176:179], v[148:151], 0
    s_waitcnt lgkmcnt(2)
    v_mfma_f32_32x32x16_bf16 v[80:95], v[180:183], v[152:155], v[80:95]
    s_waitcnt lgkmcnt(1)
    v_mfma_f32_32x32x16_bf16 v[80:95], v[184:187], v[156:159], v[80:95]
    s_waitcnt lgkmcnt(0)
    v_mfma_f32_32x32x16_bf16 v[80:95], v[188:191], v[160:163], v[80:95]
    s_nop 7
    s_nop 3
    v_pk_mul_f32 v[80:81], v[80:81], v[12:13] op_sel_hi:[1,0]
    v_cvt_pk_bf16_f32 v48, v80, v81
    v_pk_mul_f32 v[82:83], v[82:83], v[12:13] op_sel_hi:[1,0]
    v_cvt_pk_bf16_f32 v49, v82, v83
    v_pk_mul_f32 v[84:85], v[84:85], v[12:13] op_sel_hi:[1,0]
    v_cvt_pk_bf16_f32 v50, v84, v85
    v_pk_mul_f32 v[86:87], v[86:87], v[12:13] op_sel_hi:[1,0]
    v_cvt_pk_bf16_f32 v51, v86, v87
    buffer_store_dwordx4 v[48:51], v226, s[36:39], s10 offen offset:0 sc1
    v_pk_mul_f32 v[88:89], v[88:89], v[12:13] op_sel_hi:[1,0]
    v_cvt_pk_bf16_f32 v52, v88, v89
    v_pk_mul_f32 v[90:91], v[90:91], v[12:13] op_sel_hi:[1,0]
    v_cvt_pk_bf16_f32 v53, v90, v91
    v_pk_mul_f32 v[92:93], v[92:93], v[12:13] op_sel_hi:[1,0]
    v_cvt_pk_bf16_f32 v54, v92, v93
    v_pk_mul_f32 v[94:95], v[94:95], v[12:13] op_sel_hi:[1,0]
    v_cvt_pk_bf16_f32 v55, v94, v95
    buffer_store_dwordx4 v[52:55], v226, s[36:39], s10 offen offset:1024 sc1
    s_add_u32 s72, s11, 57344
    buffer_load_dwordx4 v[176:179], v226, s[36:39], s72 offen offset:0 sc1
    s_add_u32 s72, s11, 57344
    buffer_load_dwordx4 v[180:183], v226, s[36:39], s72 offen offset:1024 sc1
    s_add_u32 s72, s11, 65536
    buffer_load_dwordx4 v[184:187], v226, s[36:39], s72 offen offset:0 sc1
    s_add_u32 s72, s11, 65536
    buffer_load_dwordx4 v[188:191], v226, s[36:39], s72 offen offset:1024 sc1
    s_waitcnt vmcnt(12) lgkmcnt(0)
    s_barrier
    v_mfma_f32_32x32x16_bf16 v[16:31], v[64:67], v[112:115], v[16:31]
    v_add_u32 v12, 131072, v227
    v_add_u32 v13, 131072, v228
    ds_read_b64_tr_b16 v[128:129], v12 offset:0
    ds_read_b64_tr_b16 v[130:131], v12 offset:1024
    v_mfma_f32_32x32x16_bf16 v[32:47], v[68:71], v[112:115], v[32:47]
    ds_read_b64_tr_b16 v[132:133], v13 offset:0
    ds_read_b64_tr_b16 v[134:135], v13 offset:1024
    s_add_u32 s72, s11, 73728
    buffer_load_dwordx4 v[192:195], v226, s[36:39], s72 offen offset:0 sc1
    v_mfma_f32_32x32x16_bf16 v[16:31], v[72:75], v[116:119], v[16:31]
    ds_read_b64_tr_b16 v[136:137], v12 offset:2048
    ds_read_b64_tr_b16 v[138:139], v12 offset:3072
    ds_read_b64_tr_b16 v[200:201], v13 offset:2048
    v_mfma_f32_32x32x16_bf16 v[32:47], v[76:79], v[116:119], v[32:47]
    ds_read_b64_tr_b16 v[202:203], v13 offset:3072
    s_add_u32 s72, s11, 73728
    buffer_load_dwordx4 v[204:207], v226, s[36:39], s72 offen offset:1024 sc1
    s_waitcnt vmcnt(12) lgkmcnt(0)
    v_mfma_f32_32x32x16_bf16 v[16:31], v[128:131], v[120:123], v[16:31]
    v_add_u32 v12, 147456, v227
    v_add_u32 v13, 147456, v228
    ds_read_b64_tr_b16 v[64:65], v12 offset:0
    ds_read_b64_tr_b16 v[66:67], v12 offset:1024
    v_mfma_f32_32x32x16_bf16 v[32:47], v[132:135], v[120:123], v[32:47]
    ds_read_b64_tr_b16 v[68:69], v13 offset:0
    ds_read_b64_tr_b16 v[70:71], v13 offset:1024
    s_add_u32 s72, s11, 81920
    buffer_load_dwordx4 v[208:211], v226, s[36:39], s72 offen offset:0 sc1
    v_mfma_f32_32x32x16_bf16 v[16:31], v[136:139], v[124:127], v[16:31]
    ds_read_b64_tr_b16 v[72:73], v12 offset:2048
    ds_read_b64_tr_b16 v[74:75], v12 offset:3072
    ds_read_b64_tr_b16 v[76:77], v13 offset:2048
    v_mfma_f32_32x32x16_bf16 v[32:47], v[200:203], v[124:127], v[32:47]
    ds_read_b64_tr_b16 v[78:79], v13 offset:3072
    s_add_u32 s72, s11, 81920
    buffer_load_dwordx4 v[212:215], v226, s[36:39], s72 offen offset:1024 sc1
    s_waitcnt vmcnt(12) lgkmcnt(0)
    s_waitcnt vmcnt(8)
    s_barrier
    s_cmp_eq_u32 s64, 0
    s_cselect_b32 s72, s6, 1073741824
    v_mov_b32 v14, s80
    buffer_store_dword v14, v198, s[36:39], s72 offen sc1
    v_mfma_f32_32x32x16_bf16 v[16:31], v[64:67], v[144:147], v[16:31]
    v_add_u32 v12, 65536, v227
    v_add_u32 v13, 65536, v228
    ds_read_b64_tr_b16 v[128:129], v12 offset:0
    ds_read_b64_tr_b16 v[130:131], v12 offset:1024
    v_mfma_f32_32x32x16_bf16 v[32:47], v[68:71], v[144:147], v[32:47]
    ds_read_b64_tr_b16 v[132:133], v13 offset:0
    ds_read_b64_tr_b16 v[134:135], v13 offset:1024
    s_mov_b32 s72, 0
    s_add_u32 m0, s76, 16384
    s_nop 0
    buffer_load_dwordx4 v142, s[48:51], s72 offen lds
    v_mfma_f32_32x32x16_bf16 v[16:31], v[72:75], v[164:167], v[16:31]
    ds_read_b64_tr_b16 v[136:137], v12 offset:2048
    ds_read_b64_tr_b16 v[138:139], v12 offset:3072
    ds_read_b64_tr_b16 v[200:201], v13 offset:2048
    v_mfma_f32_32x32x16_bf16 v[32:47], v[76:79], v[164:167], v[32:47]
    ds_read_b64_tr_b16 v[202:203], v13 offset:3072
    s_mov_b32 s72, 0
    s_add_u32 m0, s76, 17408
    s_nop 0
    buffer_load_dwordx4 v143, s[48:51], s72 offen lds
    s_waitcnt lgkmcnt(0)
    v_mfma_f32_32x32x16_bf16 v[16:31], v[128:131], v[168:171], v[16:31]
    v_add_u32 v12, 81920, v227
    v_add_u32 v13, 81920, v228
    ds_read_b64_tr_b16 v[64:65], v12 offset:0
    ds_read_b64_tr_b16 v[66:67], v12 offset:1024
    v_mfma_f32_32x32x16_bf16 v[32:47], v[132:135], v[168:171], v[32:47]
    ds_read_b64_tr_b16 v[68:69], v13 offset:0
    ds_read_b64_tr_b16 v[70:71], v13 offset:1024
    s_mov_b32 s72, 131072
    s_add_u32 m0, s76, 32768
    s_nop 0
    buffer_load_dwordx4 v142, s[48:51], s72 offen lds
    v_mfma_f32_32x32x16_bf16 v[16:31], v[136:139], v[172:175], v[16:31]
    ds_read_b64_tr_b16 v[72:73], v12 offset:2048
    ds_read_b64_tr_b16 v[74:75], v12 offset:3072
    ds_read_b64_tr_b16 v[76:77], v13 offset:2048
    v_mfma_f32_32x32x16_bf16 v[32:47], v[200:203], v[172:175], v[32:47]
    ds_read_b64_tr_b16 v[78:79], v13 offset:3072
    s_mov_b32 s72, 131072
    s_add_u32 m0, s76, 33792
    s_nop 0
    buffer_load_dwordx4 v143, s[48:51], s72 offen lds
    s_waitcnt vmcnt(11) lgkmcnt(0)
    v_mfma_f32_32x32x16_bf16 v[16:31], v[64:67], v[176:179], v[16:31]
    v_add_u32 v12, 98304, v227
    v_add_u32 v13, 98304, v228
    ds_read_b64_tr_b16 v[128:129], v12 offset:0
    ds_read_b64_tr_b16 v[130:131], v12 offset:1024
    v_mfma_f32_32x32x16_bf16 v[32:47], v[68:71], v[176:179], v[32:47]
    ds_read_b64_tr_b16 v[132:133], v13 offset:0
    ds_read_b64_tr_b16 v[134:135], v13 offset:1024
    s_mov_b32 s72, 262144
    s_add_u32 m0, s76, 49152
    s_nop 0
    buffer_load_dwordx4 v142, s[48:51], s72 offen lds
    v_mfma_f32_32x32x16_bf16 v[16:31], v[72:75], v[180:183], v[16:31]
    ds_read_b64_tr_b16 v[136:137], v12 offset:2048
    ds_read_b64_tr_b16 v[138:139], v12 offset:3072
    ds_read_b64_tr_b16 v[200:201], v13 offset:2048
    v_mfma_f32_32x32x16_bf16 v[32:47], v[76:79], v[180:183], v[32:47]
    ds_read_b64_tr_b16 v[202:203], v13 offset:3072
    s_mov_b32 s72, 262144
    s_add_u32 m0, s76, 50176
    s_nop 0
    buffer_load_dwordx4 v143, s[48:51], s72 offen lds
    s_waitcnt vmcnt(11) lgkmcnt(0)
    s_barrier
    v_mfma_f32_32x32x16_bf16 v[16:31], v[128:131], v[184:187], v[16:31]
    ds_read_b64_tr_b16 v[64:65], v227 offset:0
    ds_read_b64_tr_b16 v[66:67], v227 offset:1024
    ds_read_b64_tr_b16 v[68:69], v228 offset:0
    v_mfma_f32_32x32x16_bf16 v[32:47], v[132:135], v[184:187], v[32:47]
    ds_read_b64_tr_b16 v[70:71], v228 offset:1024
    ds_read_b64_tr_b16 v[72:73], v227 offset:2048
    s_mov_b32 s72, 393216
    s_add_u32 m0, s76, 131072
    s_nop 0
    buffer_load_dwordx4 v142, s[48:51], s72 offen lds
    v_mfma_f32_32x32x16_bf16 v[16:31], v[136:139], v[188:191], v[16:31]
    ds_read_b64_tr_b16 v[74:75], v227 offset:3072
    ds_read_b64_tr_b16 v[76:77], v228 offset:2048
    v_mfma_f32_32x32x16_bf16 v[32:47], v[200:203], v[188:191], v[32:47]
    ds_read_b64_tr_b16 v[78:79], v228 offset:3072
    s_mov_b32 s72, 393216
    s_add_u32 m0, s76, 132096
    s_nop 0
    buffer_load_dwordx4 v143, s[48:51], s72 offen lds
    s_waitcnt vmcnt(11) lgkmcnt(0)
    s_mov_b32 s72, 4096
    buffer_load_dword v15, v197, s[36:39], s72 offen sc1
    v_mfma_f32_32x32x16_bf16 v[16:31], v[64:67], v[192:195], v[16:31]
    v_add_u32 v12, 118784, v227
    v_add_u32 v13, 118784, v228
    ds_read_b64_tr_b16 v[128:129], v12 offset:0
    ds_read_b64_tr_b16 v[130:131], v12 offset:1024
    v_mfma_f32_32x32x16_bf16 v[32:47], v[68:71], v[192:195], v[32:47]
    ds_read_b64_tr_b16 v[132:133], v13 offset:0
    ds_read_b64_tr_b16 v[134:135], v13 offset:1024
    v_mfma_f32_32x32x16_bf16 v[16:31], v[72:75], v[204:207], v[16:31]
    ds_read_b64_tr_b16 v[136:137], v12 offset:2048
    ds_read_b64_tr_b16 v[138:139], v12 offset:3072
    v_mfma_f32_32x32x16_bf16 v[32:47], v[76:79], v[204:207], v[32:47]
    ds_read_b64_tr_b16 v[200:201], v13 offset:2048
    ds_read_b64_tr_b16 v[202:203], v13 offset:3072
    s_waitcnt vmcnt(10) lgkmcnt(0)
    s_cmp_eq_u32 s65, 3
    s_cbranch_scc1 L_skip100
    v_mfma_f32_32x32x16_bf16 v[16:31], v[128:131], v[208:211], v[16:31]
    v_mfma_f32_32x32x16_bf16 v[32:47], v[132:135], v[208:211], v[32:47]
    v_mfma_f32_32x32x16_bf16 v[16:31], v[136:139], v[212:215], v[16:31]
    v_mfma_f32_32x32x16_bf16 v[32:47], v[200:203], v[212:215], v[32:47]
L_skip100:
    s_nop 7
    s_nop 2
    v_pk_add_f32 v[16:17], v[16:17], v[244:245]
    v_pk_add_f32 v[18:19], v[18:19], v[246:247]
    v_pk_add_f32 v[20:21], v[20:21], v[248:249]
    v_pk_add_f32 v[22:23], v[22:23], v[250:251]
    s_branch L_p2
L_mlp:
    s_lshl_b32 s73, s66, 6
    s_add_u32 s72, s81, s73
    v_lshl_add_u32 v254, v2, 1, s72
    s_lshl_b32 s72, s68, 2
    s_add_u32 s72, s72, s65
    s_mul_i32 s72, s72, 88
    s_mul_i32 s73, s69, 11
    s_add_u32 s72, s72, s73
    s_lshl_b32 s73, s66, 1
    s_add_u32 s72, s72, s73
    s_lshl_b32 s72, s72, 10
    s_add_u32 s10, s72, 1048576
    s_cmp_eq_u32 s69, 7
    s_cselect_b32 s75, 9, 11
    s_sub_u32 s75, s75, s73
    s_add_u32 s72, s10, 8192
    s_cmp_gt_i32 s75, 8
    s_cselect_b32 s20, s72, 1073741824
    s_add_u32 s72, s10, 9216
    s_cmp_gt_i32 s75, 9
    s_cselect_b32 s21, s72, 1073741824
    s_add_u32 s22, s10, 4096
    s_waitcnt vmcnt(11)
    v_dot2_f32_bf16 v4, v8, s90, 0
    v_dot2_f32_bf16 v5, v8, v8, 0
    v_dot2_f32_bf16 v4, v9, s90, v4
    v_dot2_f32_bf16 v5, v9, v9, v5
    v_dot2_f32_bf16 v4, v10, s90, v4
    v_dot2_f32_bf16 v5, v10, v10, v5
    v_dot2_f32_bf16 v4, v11, s90, v4
    v_dot2_f32_bf16 v5, v11, v11, v5
    s_nop 1
    v_add_f32_dpp v4, v4, v4 quad_perm:[1,0,3,2] row_mask:0xf bank_mask:0xf
    v_add_f32_dpp v5, v5, v5 quad_perm:[1,0,3,2] row_mask:0xf bank_mask:0xf
    s_nop 0
    v_add_f32_dpp v4, v4, v4 quad_perm:[2,3,0,1] row_mask:0xf bank_mask:0xf
    v_add_f32_dpp v5, v5, v5 quad_perm:[2,3,0,1] row_mask:0xf bank_mask:0xf
    s_nop 0
    v_add_f32_dpp v4, v4, v4 row_half_mirror row_mask:0xf bank_mask:0xf
    v_add_f32_dpp v5, v5, v5 row_half_mirror row_mask:0xf bank_mask:0xf
    s_nop 0
    v_add_f32_dpp v4, v4, v4 row_mirror row_mask:0xf bank_mask:0xf
    v_add_f32_dpp v5, v5, v5 row_mirror row_mask:0xf bank_mask:0xf
    s_nop 0
    v_add_f32_dpp v4, v4, v4 row_bcast:15 row_mask:0xa bank_mask:0xf
    v_add_f32_dpp v5, v5, v5 row_bcast:15 row_mask:0xa bank_mask:0xf
    s_nop 0
    v_add_f32_dpp v4, v4, v4 row_bcast:31 row_mask:0xc bank_mask:0xf
    v_add_f32_dpp v5, v5, v5 row_bcast:31 row_mask:0xc bank_mask:0xf
    v_mul_f32 v4, 0xbb000000, v4
    v_mul_f32 v5, 0x3b000000, v5
    v_fma_f32 v5, -v4, v4, v5
    v_max_f32 v5, 0, v5
    v_add_f32 v6, s95, v5
    v_rsq_f32 v201, v6
    v_cvt_pk_bf16_f32 v6, v4, v4
    v_and_b32 v6, 0xffff0000, v6
    v_sub_f32 v6, v4, v6
    v_cvt_pk_bf16_f32 v200, v4, v6
    v_mov_b32 v204, v200
    v_mul_f32 v202, 0x3fb8aa3b, v201
    v_mul_f32 v5, v5, v201
    v_fma_f32 v5, v5, v201, s95
    v_rsq_f32 v5, v5
    s_nop 0
    v_mul_f32 v206, v5, v201
    v_rcp_f32 v5, v206
    s_nop 0
    v_cvt_pk_bf16_f32 v6, v5, v5
    v_and_b32 v6, 0xffff0000, v6
    v_sub_f32 v6, v5, v6
    v_cvt_pk_bf16_f32 v205, v5, v6
    buffer_load_dword v199, v198, s[56:59], 0 offen sc1
    s_add_u32 s100, s70, 2
    s_and_b32 s100, s100, 7
    s_mul_i32 s101, s100, s84
    s_lshl_b32 s100, s100, 7
    s_add_u32 m0, s76, 81920
    s_nop 0
    buffer_load_dwordx4 v138, s[28:31], s100 offen lds
    s_add_u32 m0, s76, 82944
    s_nop 0
    buffer_load_dwordx4 v139, s[28:31], s100 offen lds
    s_add_u32 m0, s77, 98304
    s_add_u32 s74, s101, s81
    buffer_load_dwordx4 v140, s[32:35], s74 offen lds
    s_add_u32 m0, s77, 106496
    s_add_u32 s74, s101, s82
    buffer_load_dwordx4 v140, s[32:35], s74 offen lds
    s_add_u32 m0, s77, 114688
    s_add_u32 s74, s101, s83
    buffer_load_dwordx4 v141, s[32:35], s74 offen lds
    s_waitcnt vmcnt(12)
    s_barrier
    ds_read_b128 v[64:67], v128 offset:0
    ds_read_b64_tr_b16 v[68:69], v136 offset:0
    ds_read_b64_tr_b16 v[70:71], v136 offset:512
    ds_read_b64_tr_b16 v[72:73], v136 offset:8192
    ds_read_b64_tr_b16 v[74:75], v136 offset:8704
    ds_read_b64_tr_b16 v[76:77], v136 offset:16384
    ds_read_b64_tr_b16 v[78:79], v136 offset:16896
    ds_read_b128 v[80:83], v129 offset:0
    ds_read_b64_tr_b16 v[84:85], v136 offset:2048
    ds_read_b64_tr_b16 v[86:87], v136 offset:2560
    ds_read_b64_tr_b16 v[88:89], v136 offset:10240
    ds_read_b64_tr_b16 v[90:91], v136 offset:10752
    ds_read_b64_tr_b16 v[92:93], v136 offset:18432
    ds_read_b64_tr_b16 v[94:95], v136 offset:18944
    s_waitcnt lgkmcnt(7)
    v_mfma_f32_32x32x16_bf16 v[16:31], v[68:71], v[64:67], 0
    ds_read_b128 v[96:99], v130 offset:0
    ds_read_b64_tr_b16 v[100:101], v136 offset:4096
    ds_read_b64_tr_b16 v[102:103], v136 offset:4608
    s_cmp_lg_u32 s89, 0
    s_cbranch_scc1 CD_17
    v_dot2_f32_bf16 v196, v68, s90, v196
    v_dot2_f32_bf16 v196, v69, s90, v196
    v_dot2_f32_bf16 v196, v70, s90, v196
    v_dot2_f32_bf16 v196, v71, s90, v196
CD_17:
    s_add_u32 s100, s70, 3
    s_and_b32 s100, s100, 7
    s_mul_i32 s101, s100, s84
    s_lshl_b32 s100, s100, 7
    s_add_u32 m0, s76, 122880
    s_nop 0
    buffer_load_dwordx4 v138, s[28:31], s100 offen lds
    v_mfma_f32_32x32x16_bf16 v[32:47], v[72:75], v[64:67], 0
    ds_read_b64_tr_b16 v[104:105], v136 offset:12288
    ds_read_b64_tr_b16 v[106:107], v136 offset:12800
    s_cmp_lg_u32 s89, 1
    s_cbranch_scc1 CD_18
    v_dot2_f32_bf16 v196, v72, s90, v196
    v_dot2_f32_bf16 v196, v73, s90, v196
    v_dot2_f32_bf16 v196, v74, s90, v196
    v_dot2_f32_bf16 v196, v75, s90, v196
CD_18:
    v_mfma_f32_32x32x16_bf16 v[48:63], v[76:79], v[64:67], 0
    ds_read_b64_tr_b16 v[108:109], v136 offset:20480
    ds_read_b64_tr_b16 v[110:111], v136 offset:20992
    s_cmp_lg_u32 s89, 2
    s_cbranch_scc1 CD_19
    v_dot2_f32_bf16 v196, v76, s90, v196
    v_dot2_f32_bf16 v196, v77, s90, v196
    v_dot2_f32_bf16 v196, v78, s90, v196
    v_dot2_f32_bf16 v196, v79, s90, v196
CD_19:
    s_add_u32 m0, s76, 123904
    s_nop 0
    buffer_load_dwordx4 v139, s[28:31], s100 offen lds
    s_waitcnt lgkmcnt(7)
    v_mfma_f32_32x32x16_bf16 v[16:31], v[84:87], v[80:83], v[16:31]
    ds_read_b128 v[112:115], v131 offset:0
    ds_read_b64_tr_b16 v[116:117], v136 offset:6144
    ds_read_b64_tr_b16 v[118:119], v136 offset:6656
    s_cmp_lg_u32 s89, 0
    s_cbranch_scc1 CD_20
    v_dot2_f32_bf16 v196, v84, s90, v196
    v_dot2_f32_bf16 v196, v85, s90, v196
    v_dot2_f32_bf16 v196, v86, s90, v196
    v_dot2_f32_bf16 v196, v87, s90, v196
CD_20:
    v_mfma_f32_32x32x16_bf16 v[32:47], v[88:91], v[80:83], v[32:47]
    ds_read_b64_tr_b16 v[120:121], v136 offset:14336
    ds_read_b64_tr_b16 v[122:123], v136 offset:14848
    s_cmp_lg_u32 s89, 1
    s_cbranch_scc1 CD_21
    v_dot2_f32_bf16 v196, v88, s90, v196
    v_dot2_f32_bf16 v196, v89, s90, v196
    v_dot2_f32_bf16 v196, v90, s90, v196
    v_dot2_f32_bf16 v196, v91, s90, v196
CD_21:
    s_add_u32 m0, s77, 139264
    s_add_u32 s74, s101, s81
    buffer_load_dwordx4 v140, s[32:35], s74 offen lds
    v_mfma_f32_32x32x16_bf16 v[48:63], v[92:95], v[80:83], v[48:63]
    ds_read_b64_tr_b16 v[124:125], v136 offset:22528
    ds_read_b64_tr_b16 v[126:127], v136 offset:23040
    s_cmp_lg_u32 s89, 2
    s_cbranch_scc1 CD_22
    v_dot2_f32_bf16 v196, v92, s90, v196
    v_dot2_f32_bf16 v196, v93, s90, v196
    v_dot2_f32_bf16 v196, v94, s90, v196
    v_dot2_f32_bf16 v196, v95, s90, v196
CD_22:
    s_waitcnt vmcnt(8) lgkmcnt(7)
    s_barrier
    v_mfma_f32_32x32x16_bf16 v[16:31], v[100:103], v[96:99], v[16:31]
    ds_read_b128 v[64:67], v128 offset:40960
    ds_read_b64_tr_b16 v[68:69], v136 offset:40960
    ds_read_b64_tr_b16 v[70:71], v136 offset:41472
    s_cmp_lg_u32 s89, 0
    s_cbranch_scc1 CD_23
    v_dot2_f32_bf16 v196, v100, s90, v196
    v_dot2_f32_bf16 v196, v101, s90, v196
    v_dot2_f32_bf16 v196, v102, s90, v196
    v_dot2_f32_bf16 v196, v103, s90, v196
CD_23:
    s_add_u32 m0, s77, 147456
    s_add_u32 s74, s101, s82
    buffer_load_dwordx4 v140, s[32:35], s74 offen lds
    v_mfma_f32_32x32x16_bf16 v[32:47], v[104:107], v[96:99], v[32:47]
    ds_read_b64_tr_b16 v[72:73], v136 offset:49152
    ds_read_b64_tr_b16 v[74:75], v136 offset:49664
    s_cmp_lg_u32 s89, 1
    s_cbranch_scc1 CD_24
    v_dot2_f32_bf16 v196, v104, s90, v196
    v_dot2_f32_bf16 v196, v105, s90, v196
    v_dot2_f32_bf16 v196, v106, s90, v196
    v_dot2_f32_bf16 v196, v107, s90, v196
CD_24:
    v_mfma_f32_32x32x16_bf16 v[48:63], v[108:111], v[96:99], v[48:63]
    ds_read_b64_tr_b16 v[76:77], v136 offset:57344
    ds_read_b64_tr_b16 v[78:79], v136 offset:57856
    s_cmp_lg_u32 s89, 2
    s_cbranch_scc1 CD_25
    v_dot2_f32_bf16 v196, v108, s90, v196
    v_dot2_f32_bf16 v196, v109, s90, v196
    v_dot2_f32_bf16 v196, v110, s90, v196
    v_dot2_f32_bf16 v196, v111, s90, v196
CD_25:
    s_add_u32 m0, s77, 155648
    s_add_u32 s74, s101, s83
    buffer_load_dwordx4 v141, s[32:35], s74 offen lds
    s_waitcnt lgkmcnt(7)
    v_mfma_f32_32x32x16_bf16 v[16:31], v[116:119], v[112:115], v[16:31]
    ds_read_b128 v[80:83], v129 offset:40960
    ds_read_b64_tr_b16 v[84:85], v136 offset:43008
    ds_read_b64_tr_b16 v[86:87], v136 offset:43520
    s_cmp_lg_u32 s89, 0
    s_cbranch_scc1 CD_26
    v_dot2_f32_bf16 v196, v116, s90, v196
    v_dot2_f32_bf16 v196, v117, s90, v196
    v_dot2_f32_bf16 v196, v118, s90, v196
    v_dot2_f32_bf16 v196, v119, s90, v196
CD_26:
    v_mfma_f32_32x32x16_bf16 v[32:47], v[120:123], v[112:115], v[32:47]
    ds_read_b64_tr_b16 v[88:89], v136 offset:51200
    ds_read_b64_tr_b16 v[90:91], v136 offset:51712
    s_cmp_lg_u32 s89, 1
    s_cbranch_scc1 CD_27
    v_dot2_f32_bf16 v196, v120, s90, v196
    v_dot2_f32_bf16 v196, v121, s90, v196
    v_dot2_f32_bf16 v196, v122, s90, v196
    v_dot2_f32_bf16 v196, v123, s90, v196
CD_27:
    v_mfma_f32_32x32x16_bf16 v[48:63], v[124:127], v[112:115], v[48:63]
    ds_read_b64_tr_b16 v[92:93], v136 offset:59392
    ds_read_b64_tr_b16 v[94:95], v136 offset:59904
    s_cmp_lg_u32 s89, 2
    s_cbranch_scc1 CD_28
    v_dot2_f32_bf16 v196, v124, s90, v196
    v_dot2_f32_bf16 v196, v125, s90, v196
    v_dot2_f32_bf16 v196, v126, s90, v196
    v_dot2_f32_bf16 v196, v127, s90, v196
CD_28:
    s_lshl_b32 s72, s2, 13
    s_add_u32 s72, s72, s77
    s_sub_u32 s73, s72, 1409024
    s_cmp_lt_u32 s72, 1409024
    s_cbranch_scc0 L_pfo1
    buffer_load_dwordx4 v[8:11], v226, s[44:47], s72 offen
    s_branch L_pfd1
L_pfo1:
    buffer_load_dwordx4 v[8:11], v226, s[48:51], s73 offen
L_pfd1:
    s_waitcnt lgkmcnt(7)
    v_mfma_f32_32x32x16_bf16 v[16:31], v[68:71], v[64:67], v[16:31]
    ds_read_b128 v[96:99], v130 offset:40960
    ds_read_b64_tr_b16 v[100:101], v136 offset:45056
    ds_read_b64_tr_b16 v[102:103], v136 offset:45568
    v_mfma_f32_32x32x16_bf16 v[32:47], v[72:75], v[64:67], v[32:47]
    ds_read_b64_tr_b16 v[104:105], v136 offset:53248
    ds_read_b64_tr_b16 v[106:107], v136 offset:53760
    v_readfirstlane_b32 s80, v199
    s_mov_b32 s73, 0
EP_29:
    s_cmp_lg_u32 s80, 0
    s_cbranch_scc1 EP_29d
    s_add_u32 s73, s73, 1
    s_cmp_gt_u32 s73, 20000
    s_cbranch_scc1 EP_29d
    buffer_load_dword v199, v198, s[56:59], 0 offen sc1
    s_waitcnt vmcnt(0)
    v_readfirstlane_b32 s80, v199
    s_branch EP_29
EP_29d:
    v_mov_b32 v4, v196
    v_mov_b32 v203, s80
    v_mov_b32 v207, s80
    v_permlane32_swap_b32 v4, v196
    v_mov_b32 v5, s80
    s_mov_b32 s72, 0x8000
    v_add_f32 v4, v4, v196
    buffer_store_dwordx4 v[200:203], v208, s[36:39], 0 offen sc1
    buffer_store_dwordx4 v[204:207], v208, s[36:39], s72 offen sc1
    buffer_store_dwordx2 v[4:5], v209, s[36:39], s94 offen sc1
    v_mfma_f32_32x32x16_bf16 v[48:63], v[76:79], v[64:67], v[48:63]
    ds_read_b64_tr_b16 v[108:109], v136 offset:61440
    ds_read_b64_tr_b16 v[110:111], v136 offset:61952
    s_waitcnt lgkmcnt(7)
    v_mfma_f32_32x32x16_bf16 v[16:31], v[84:87], v[80:83], v[16:31]
    ds_read_b128 v[112:115], v131 offset:40960
    ds_read_b64_tr_b16 v[116:117], v136 offset:47104
    ds_read_b64_tr_b16 v[118:119], v136 offset:47616
    buffer_load_ushort v148, v254, s[40:43], 0 offen offset:0
    v_mfma_f32_32x32x16_bf16 v[32:47], v[88:91], v[80:83], v[32:47]
    ds_read_b64_tr_b16 v[120:121], v136 offset:55296
    ds_read_b64_tr_b16 v[122:123], v136 offset:55808
    v_mfma_f32_32x32x16_bf16 v[48:63], v[92:95], v[80:83], v[48:63]
    ds_read_b64_tr_b16 v[124:125], v136 offset:63488
    ds_read_b64_tr_b16 v[126:127], v136 offset:64000
    buffer_load_ushort v149, v254, s[40:43], 0 offen offset:128
    s_waitcnt vmcnt(11) lgkmcnt(7)
    s_barrier
    v_mfma_f32_32x32x16_bf16 v[16:31], v[100:103], v[96:99], v[16:31]
    ds_read_b128 v[64:67], v132 offset:0
    ds_read_b64_tr_b16 v[68:69], v137 offset:0
    ds_read_b64_tr_b16 v[70:71], v137 offset:512
    s_add_u32 s100, s70, 4
    s_and_b32 s100, s100, 7
    s_mul_i32 s101, s100, s84
    s_lshl_b32 s100, s100, 7
    s_add_u32 m0, s76, 0
    s_nop 0
    buffer_load_dwordx4 v138, s[28:31], s100 offen lds
    v_mfma_f32_32x32x16_bf16 v[32:47], v[104:107], v[96:99], v[32:47]
    ds_read_b64_tr_b16 v[72:73], v137 offset:8192
    ds_read_b64_tr_b16 v[74:75], v137 offset:8704
    buffer_load_ushort v150, v254, s[40:43], 0 offen offset:256
    v_mfma_f32_32x32x16_bf16 v[48:63], v[108:111], v[96:99], v[48:63]
    ds_read_b64_tr_b16 v[76:77], v137 offset:16384
    ds_read_b64_tr_b16 v[78:79], v137 offset:16896
    s_add_u32 m0, s76, 1024
    s_nop 0
    buffer_load_dwordx4 v139, s[28:31], s100 offen lds
    s_waitcnt lgkmcnt(7)
    v_mfma_f32_32x32x16_bf16 v[16:31], v[116:119], v[112:115], v[16:31]
    ds_read_b128 v[80:83], v133 offset:0
    ds_read_b64_tr_b16 v[84:85], v137 offset:2048
    ds_read_b64_tr_b16 v[86:87], v137 offset:2560
    buffer_load_dwordx4 v[236:239], v235, s[28:31], 0 offen
    v_mfma_f32_32x32x16_bf16 v[32:47], v[120:123], v[112:115], v[32:47]
    ds_read_b64_tr_b16 v[88:89], v137 offset:10240
    ds_read_b64_tr_b16 v[90:91], v137 offset:10752
    s_add_u32 m0, s77, 16384
    s_add_u32 s74, s101, s81
    buffer_load_dwordx4 v140, s[32:35], s74 offen lds
    v_mfma_f32_32x32x16_bf16 v[48:63], v[124:127], v[112:115], v[48:63]
    ds_read_b64_tr_b16 v[92:93], v137 offset:18432
    ds_read_b64_tr_b16 v[94:95], v137 offset:18944
    buffer_load_dwordx2 v[244:245], v253, s[60:63], 0 offen offset:0
    s_waitcnt lgkmcnt(7)
    v_mfma_f32_32x32x16_bf16 v[16:31], v[68:71], v[64:67], v[16:31]
    ds_read_b128 v[96:99], v134 offset:0
    ds_read_b64_tr_b16 v[100:101], v137 offset:4096
    ds_read_b64_tr_b16 v[102:103], v137 offset:4608
    s_add_u32 m0, s77, 24576
    s_add_u32 s74, s101, s82
    buffer_load_dwordx4 v140, s[32:35], s74 offen lds
    v_mfma_f32_32x32x16_bf16 v[32:47], v[72:75], v[64:67], v[32:47]
    ds_read_b64_tr_b16 v[104:105], v137 offset:12288
    ds_read_b64_tr_b16 v[106:107], v137 offset:12800
    buffer_load_dwordx2 v[248:249], v253, s[60:63], 0 offen offset:16
    v_mfma_f32_32x32x16_bf16 v[48:63], v[76:79], v[64:67], v[48:63]
    ds_read_b64_tr_b16 v[108:109], v137 offset:20480
    ds_read_b64_tr_b16 v[110:111], v137 offset:20992
    s_add_u32 m0, s77, 32768
    s_add_u32 s74, s101, s83
    buffer_load_dwordx4 v141, s[32:35], s74 offen lds
    s_waitcnt lgkmcnt(7)
    v_mfma_f32_32x32x16_bf16 v[16:31], v[84:87], v[80:83], v[16:31]
    ds_read_b128 v[112:115], v135 offset:0
    ds_read_b64_tr_b16 v[116:117], v137 offset:6144
    ds_read_b64_tr_b16 v[118:119], v137 offset:6656
    v_mfma_f32_32x32x16_bf16 v[32:47], v[88:91], v[80:83], v[32:47]
    ds_read_b64_tr_b16 v[120:121], v137 offset:14336
    ds_read_b64_tr_b16 v[122:123], v137 offset:14848
    v_mfma_f32_32x32x16_bf16 v[48:63], v[92:95], v[80:83], v[48:63]
    ds_read_b64_tr_b16 v[124:125], v137 offset:22528
    ds_read_b64_tr_b16 v[126:127], v137 offset:23040
    s_waitcnt vmcnt(15) lgkmcnt(7)
    s_barrier
    v_mfma_f32_32x32x16_bf16 v[16:31], v[100:103], v[96:99], v[16:31]
    ds_read_b128 v[64:67], v132 offset:40960
    ds_read_b64_tr_b16 v[68:69], v137 offset:40960
    ds_read_b64_tr_b16 v[70:71], v137 offset:41472
    s_add_u32 s100, s70, 5
    s_and_b32 s100, s100, 7
    s_mul_i32 s101, s100, s84
    s_lshl_b32 s100, s100, 7
    s_add_u32 m0, s76, 40960
    s_nop 0
    buffer_load_dwordx4 v138, s[28:31], s100 offen lds
    v_mfma_f32_32x32x16_bf16 v[32:47], v[104:107], v[96:99], v[32:47]
    ds_read_b64_tr_b16 v[72:73], v137 offset:49152
    ds_read_b64_tr_b16 v[74:75], v137 offset:49664
    v_mfma_f32_32x32x16_bf16 v[48:63], v[108:111], v[96:99], v[48:63]
    ds_read_b64_tr_b16 v[76:77], v137 offset:57344
    ds_read_b64_tr_b16 v[78:79], v137 offset:57856
    s_add_u32 m0, s76, 41984
    s_nop 0
    buffer_load_dwordx4 v139, s[28:31], s100 offen lds
    s_waitcnt lgkmcnt(7)
    v_mfma_f32_32x32x16_bf16 v[16:31], v[116:119], v[112:115], v[16:31]
    ds_read_b128 v[80:83], v133 offset:40960
    ds_read_b64_tr_b16 v[84:85], v137 offset:43008
    ds_read_b64_tr_b16 v[86:87], v137 offset:43520
    v_mfma_f32_32x32x16_bf16 v[32:47], v[120:123], v[112:115], v[32:47]
    ds_read_b64_tr_b16 v[88:89], v137 offset:51200
    ds_read_b64_tr_b16 v[90:91], v137 offset:51712
    s_add_u32 m0, s77, 57344
    s_add_u32 s74, s101, s81
    buffer_load_dwordx4 v140, s[32:35], s74 offen lds
    v_mfma_f32_32x32x16_bf16 v[48:63], v[124:127], v[112:115], v[48:63]
    ds_read_b64_tr_b16 v[92:93], v137 offset:59392
    ds_read_b64_tr_b16 v[94:95], v137 offset:59904
    s_waitcnt lgkmcnt(7)
    v_mfma_f32_32x32x16_bf16 v[16:31], v[68:71], v[64:67], v[16:31]
    ds_read_b128 v[96:99], v134 offset:40960
    ds_read_b64_tr_b16 v[100:101], v137 offset:45056
    ds_read_b64_tr_b16 v[102:103], v137 offset:45568
    s_add_u32 m0, s77, 65536
    s_add_u32 s74, s101, s82
    buffer_load_dwordx4 v140, s[32:35], s74 offen lds
    v_mfma_f32_32x32x16_bf16 v[32:47], v[72:75], v[64:67], v[32:47]
    ds_read_b64_tr_b16 v[104:105], v137 offset:53248
    ds_read_b64_tr_b16 v[106:107], v137 offset:53760
    v_mfma_f32_32x32x16_bf16 v[48:63], v[76:79], v[64:67], v[48:63]
    ds_read_b64_tr_b16 v[108:109], v137 offset:61440
    ds_read_b64_tr_b16 v[110:111], v137 offset:61952
    s_add_u32 m0, s77, 73728
    s_add_u32 s74, s101, s83
    buffer_load_dwordx4 v141, s[32:35], s74 offen lds
    s_waitcnt lgkmcnt(7)
    v_mfma_f32_32x32x16_bf16 v[16:31], v[84:87], v[80:83], v[16:31]
    ds_read_b128 v[112:115], v135 offset:40960
    ds_read_b64_tr_b16 v[116:117], v137 offset:47104
    ds_read_b64_tr_b16 v[118:119], v137 offset:47616
    v_mfma_f32_32x32x16_bf16 v[32:47], v[88:91], v[80:83], v[32:47]
    ds_read_b64_tr_b16 v[120:121], v137 offset:55296
    ds_read_b64_tr_b16 v[122:123], v137 offset:55808
    v_mfma_f32_32x32x16_bf16 v[48:63], v[92:95], v[80:83], v[48:63]
    ds_read_b64_tr_b16 v[124:125], v137 offset:63488
    ds_read_b64_tr_b16 v[126:127], v137 offset:64000
    s_waitcnt vmcnt(5) lgkmcnt(7)
    s_barrier
    v_mfma_f32_32x32x16_bf16 v[16:31], v[100:103], v[96:99], v[16:31]
    ds_read_b128 v[64:67], v128 offset:0
    ds_read_b64_tr_b16 v[68:69], v136 offset:0
    ds_read_b64_tr_b16 v[70:71], v136 offset:512
    s_add_u32 s100, s70, 6
    s_and_b32 s100, s100, 7
    s_mul_i32 s101, s100, s84
    s_lshl_b32 s100, s100, 7
    s_add_u32 m0, s76, 81920
    s_nop 0
    buffer_load_dwordx4 v138, s[28:31], s100 offen lds
    v_mfma_f32_32x32x16_bf16 v[32:47], v[104:107], v[96:99], v[32:47]
    ds_read_b64_tr_b16 v[72:73], v136 offset:8192
    ds_read_b64_tr_b16 v[74:75], v136 offset:8704
    v_mfma_f32_32x32x16_bf16 v[48:63], v[108:111], v[96:99], v[48:63]
    ds_read_b64_tr_b16 v[76:77], v136 offset:16384
    ds_read_b64_tr_b16 v[78:79], v136 offset:16896
    s_add_u32 m0, s76, 82944
    s_nop 0
    buffer_load_dwordx4 v139, s[28:31], s100 offen lds
    s_waitcnt lgkmcnt(7)
    v_mfma_f32_32x32x16_bf16 v[16:31], v[116:119], v[112:115], v[16:31]
    ds_read_b128 v[80:83], v129 offset:0
    ds_read_b64_tr_b16 v[84:85], v136 offset:2048
    ds_read_b64_tr_b16 v[86:87], v136 offset:2560
    v_mfma_f32_32x32x16_bf16 v[32:47], v[120:123], v[112:115], v[32:47]
    ds_read_b64_tr_b16 v[88:89], v136 offset:10240
    ds_read_b64_tr_b16 v[90:91], v136 offset:10752
    s_add_u32 m0, s77, 98304
    s_add_u32 s74, s101, s81
    buffer_load_dwordx4 v140, s[32:35], s74 offen lds
    v_mfma_f32_32x32x16_bf16 v[48:63], v[124:127], v[112:115], v[48:63]
    ds_read_b64_tr_b16 v[92:93], v136 offset:18432
    ds_read_b64_tr_b16 v[94:95], v136 offset:18944
    s_waitcnt lgkmcnt(7)
    v_mfma_f32_32x32x16_bf16 v[16:31], v[68:71], v[64:67], v[16:31]
    ds_read_b128 v[96:99], v130 offset:0
    ds_read_b64_tr_b16 v[100:101], v136 offset:4096
    ds_read_b64_tr_b16 v[102:103], v136 offset:4608
    s_add_u32 m0, s77, 106496
    s_add_u32 s74, s101, s82
    buffer_load_dwordx4 v140, s[32:35], s74 offen lds
    v_mfma_f32_32x32x16_bf16 v[32:47], v[72:75], v[64:67], v[32:47]
    ds_read_b64_tr_b16 v[104:105], v136 offset:12288
    ds_read_b64_tr_b16 v[106:107], v136 offset:12800
    v_mfma_f32_32x32x16_bf16 v[48:63], v[76:79], v[64:67], v[48:63]
    ds_read_b64_tr_b16 v[108:109], v136 offset:20480
    ds_read_b64_tr_b16 v[110:111], v136 offset:20992
    s_add_u32 m0, s77, 114688
    s_add_u32 s74, s101, s83
    buffer_load_dwordx4 v141, s[32:35], s74 offen lds
    s_waitcnt lgkmcnt(7)
    v_mfma_f32_32x32x16_bf16 v[16:31], v[84:87], v[80:83], v[16:31]
    ds_read_b128 v[112:115], v131 offset:0
    ds_read_b64_tr_b16 v[116:117], v136 offset:6144
    ds_read_b64_tr_b16 v[118:119], v136 offset:6656
    v_mfma_f32_32x32x16_bf16 v[32:47], v[88:91], v[80:83], v[32:47]
    ds_read_b64_tr_b16 v[120:121], v136 offset:14336
    ds_read_b64_tr_b16 v[122:123], v136 offset:14848
    v_mfma_f32_32x32x16_bf16 v[48:63], v[92:95], v[80:83], v[48:63]
    ds_read_b64_tr_b16 v[124:125], v136 offset:22528
    ds_read_b64_tr_b16 v[126:127], v136 offset:23040
    s_waitcnt vmcnt(5) lgkmcnt(7)
    s_barrier
    v_mfma_f32_32x32x16_bf16 v[16:31], v[100:103], v[96:99], v[16:31]
    ds_read_b128 v[64:67], v128 offset:40960
    ds_read_b64_tr_b16 v[68:69], v136 offset:40960
    ds_read_b64_tr_b16 v[70:71], v136 offset:41472
    s_add_u32 s100, s70, 7
    s_and_b32 s100, s100, 7
    s_mul_i32 s101, s100, s84
    s_lshl_b32 s100, s100, 7
    s_add_u32 m0, s76, 122880
    s_nop 0
    buffer_load_dwordx4 v138, s[28:31], s100 offen lds
    v_mfma_f32_32x32x16_bf16 v[32:47], v[104:107], v[96:99], v[32:47]
    ds_read_b64_tr_b16 v[72:73], v136 offset:49152
    ds_read_b64_tr_b16 v[74:75], v136 offset:49664
    v_lshl_or_b32 v178, v148, 16, v148
    v_lshl_or_b32 v182, v149, 16, v149
    v_lshl_or_b32 v186, v150, 16, v150
    v_mfma_f32_32x32x16_bf16 v[48:63], v[108:111], v[96:99], v[48:63]
    ds_read_b64_tr_b16 v[76:77], v136 offset:57344
    ds_read_b64_tr_b16 v[78:79], v136 offset:57856
    s_add_u32 m0, s76, 123904
    s_nop 0
    buffer_load_dwordx4 v139, s[28:31], s100 offen lds
    v_permlane32_swap_b32 v236, v238
    v_permlane32_swap_b32 v237, v239
    s_waitcnt lgkmcnt(7)
    v_mfma_f32_32x32x16_bf16 v[16:31], v[116:119], v[112:115], v[16:31]
    ds_read_b128 v[80:83], v129 offset:40960
    ds_read_b64_tr_b16 v[84:85], v136 offset:43008
    ds_read_b64_tr_b16 v[86:87], v136 offset:43520
    v_and_b32 v247, 0xffff0000, v245
    v_lshlrev_b32 v246, 16, v245
    v_and_b32 v245, 0xffff0000, v244
    v_mfma_f32_32x32x16_bf16 v[32:47], v[120:123], v[112:115], v[32:47]
    ds_read_b64_tr_b16 v[88:89], v136 offset:51200
    ds_read_b64_tr_b16 v[90:91], v136 offset:51712
    s_add_u32 m0, s77, 139264
    s_add_u32 s74, s101, s81
    buffer_load_dwordx4 v140, s[32:35], s74 offen lds
    v_lshlrev_b32 v244, 16, v244
    v_and_b32 v243, 0xffff0000, v239
    v_mfma_f32_32x32x16_bf16 v[48:63], v[124:127], v[112:115], v[48:63]
    ds_read_b64_tr_b16 v[92:93], v136 offset:59392
    ds_read_b64_tr_b16 v[94:95], v136 offset:59904
    v_lshlrev_b32 v242, 16, v239
    v_and_b32 v241, 0xffff0000, v238
    v_lshlrev_b32 v240, 16, v238
    s_waitcnt lgkmcnt(7)
    v_mfma_f32_32x32x16_bf16 v[16:31], v[68:71], v[64:67], v[16:31]
    ds_read_b128 v[96:99], v130 offset:40960
    ds_read_b64_tr_b16 v[100:101], v136 offset:45056
    ds_read_b64_tr_b16 v[102:103], v136 offset:45568
    s_add_u32 m0, s77, 147456
    s_add_u32 s74, s101, s82
    buffer_load_dwordx4 v140, s[32:35], s74 offen lds
    v_and_b32 v239, 0xffff0000, v237
    v_lshlrev_b32 v238, 16, v237
    v_mfma_f32_32x32x16_bf16 v[32:47], v[72:75], v[64:67], v[32:47]
    ds_read_b64_tr_b16 v[104:105], v136 offset:53248
    ds_read_b64_tr_b16 v[106:107], v136 offset:53760
    v_and_b32 v237, 0xffff0000, v236
    v_lshlrev_b32 v236, 16, v236
    v_and_b32 v251, 0xffff0000, v249
    v_mfma_f32_32x32x16_bf16 v[48:63], v[76:79], v[64:67], v[48:63]
    ds_read_b64_tr_b16 v[108:109], v136 offset:61440
    ds_read_b64_tr_b16 v[110:111], v136 offset:61952
    s_add_u32 m0, s77, 155648
    s_add_u32 s74, s101, s83
    buffer_load_dwordx4 v141, s[32:35], s74 offen lds
    v_lshlrev_b32 v250, 16, v249
    v_and_b32 v249, 0xffff0000, v248
    s_waitcnt lgkmcnt(7)
    v_mfma_f32_32x32x16_bf16 v[16:31], v[84:87], v[80:83], v[16:31]
    ds_read_b128 v[112:115], v131 offset:40960
    ds_read_b64_tr_b16 v[116:117], v136 offset:47104
    ds_read_b64_tr_b16 v[118:119], v136 offset:47616
    v_lshlrev_b32 v248, 16, v248
    v_mfma_f32_32x32x16_bf16 v[32:47], v[88:91], v[80:83], v[32:47]
    ds_read_b64_tr_b16 v[120:121], v136 offset:55296
    ds_read_b64_tr_b16 v[122:123], v136 offset:55808
    v_mfma_f32_32x32x16_bf16 v[48:63], v[92:95], v[80:83], v[48:63]
    ds_read_b64_tr_b16 v[124:125], v136 offset:63488
    ds_read_b64_tr_b16 v[126:127], v136 offset:64000
    s_waitcnt vmcnt(5) lgkmcnt(7)
    s_barrier
    v_mfma_f32_32x32x16_bf16 v[16:31], v[100:103], v[96:99], v[16:31]
    ds_read_b128 v[64:67], v132 offset:0
    ds_read_b64_tr_b16 v[68:69], v137 offset:0
    ds_read_b64_tr_b16 v[70:71], v137 offset:512
    s_mov_b32 s72, 0
    s_add_u32 m0, s76, 0
    s_nop 0
    buffer_load_dwordx4 v142, s[44:47], s72 offen lds
    v_mfma_f32_32x32x16_bf16 v[32:47], v[104:107], v[96:99], v[32:47]
    ds_read_b64_tr_b16 v[72:73], v137 offset:8192
    ds_read_b64_tr_b16 v[74:75], v137 offset:8704
    s_mov_b32 s72, 0
    s_add_u32 m0, s76, 1024
    s_nop 0
    buffer_load_dwordx4 v143, s[44:47], s72 offen lds
    v_mfma_f32_32x32x16_bf16 v[48:63], v[108:111], v[96:99], v[48:63]
    ds_read_b64_tr_b16 v[76:77], v137 offset:16384
    ds_read_b64_tr_b16 v[78:79], v137 offset:16896
    s_mov_b32 s72, 131072
    s_add_u32 m0, s76, 16384
    s_nop 0
    buffer_load_dwordx4 v142, s[44:47], s72 offen lds
    s_waitcnt lgkmcnt(7)
    v_mfma_f32_32x32x16_bf16 v[16:31], v[116:119], v[112:115], v[16:31]
    ds_read_b128 v[80:83], v133 offset:0
    ds_read_b64_tr_b16 v[84:85], v137 offset:2048
    ds_read_b64_tr_b16 v[86:87], v137 offset:2560
    s_mov_b32 s72, 131072
    s_add_u32 m0, s76, 17408
    s_nop 0
    buffer_load_dwordx4 v143, s[44:47], s72 offen lds
    v_mfma_f32_32x32x16_bf16 v[32:47], v[120:123], v[112:115], v[32:47]
    ds_read_b64_tr_b16 v[88:89], v137 offset:10240
    ds_read_b64_tr_b16 v[90:91], v137 offset:10752
    buffer_load_dwordx4 v[144:147], v210, s[36:39], 0 offen sc1
    v_mfma_f32_32x32x16_bf16 v[48:63], v[124:127], v[112:115], v[48:63]
    ds_read_b64_tr_b16 v[92:93], v137 offset:18432
    ds_read_b64_tr_b16 v[94:95], v137 offset:18944
    s_add_u32 s72, s93, 0
    buffer_load_dwordx4 v[148:151], v211, s[36:39], s72 offen offset:0 sc1
    s_waitcnt lgkmcnt(7)
    v_mfma_f32_32x32x16_bf16 v[16:31], v[68:71], v[64:67], v[16:31]
    ds_read_b128 v[96:99], v134 offset:0
    ds_read_b64_tr_b16 v[100:101], v137 offset:4096
    ds_read_b64_tr_b16 v[102:103], v137 offset:4608
    s_add_u32 s72, s93, 0
    buffer_load_dwordx4 v[152:155], v211, s[36:39], s72 offen offset:1024 sc1
    v_mfma_f32_32x32x16_bf16 v[32:47], v[72:75], v[64:67], v[32:47]
    ds_read_b64_tr_b16 v[104:105], v137 offset:12288
    ds_read_b64_tr_b16 v[106:107], v137 offset:12800
    s_add_u32 s72, s93, 4096
    buffer_load_dwordx4 v[156:159], v211, s[36:39], s72 offen offset:0 sc1
    v_mfma_f32_32x32x16_bf16 v[48:63], v[76:79], v[64:67], v[48:63]
    ds_read_b64_tr_b16 v[108:109], v137 offset:20480
    ds_read_b64_tr_b16 v[110:111], v137 offset:20992
    s_add_u32 s72, s93, 4096
    buffer_load_dwordx4 v[160:163], v211, s[36:39], s72 offen offset:1024 sc1
    s_waitcnt lgkmcnt(7)
    v_mfma_f32_32x32x16_bf16 v[16:31], v[84:87], v[80:83], v[16:31]
    ds_read_b128 v[112:115], v135 offset:0
    ds_read_b64_tr_b16 v[116:117], v137 offset:6144
    ds_read_b64_tr_b16 v[118:119], v137 offset:6656
    s_add_u32 s72, s93, 8192
    buffer_load_dwordx4 v[164:167], v211, s[36:39], s72 offen offset:0 sc1
    v_mfma_f32_32x32x16_bf16 v[32:47], v[88:91], v[80:83], v[32:47]
    ds_read_b64_tr_b16 v[120:121], v137 offset:14336
    ds_read_b64_tr_b16 v[122:123], v137 offset:14848
    s_add_u32 s72, s93, 8192
    buffer_load_dwordx4 v[168:171], v211, s[36:39], s72 offen offset:1024 sc1
    v_mfma_f32_32x32x16_bf16 v[48:63], v[92:95], v[80:83], v[48:63]
    ds_read_b64_tr_b16 v[124:125], v137 offset:22528
    ds_read_b64_tr_b16 v[126:127], v137 offset:23040
    s_waitcnt vmcnt(11) lgkmcnt(7)
    s_barrier
    v_mfma_f32_32x32x16_bf16 v[16:31], v[100:103], v[96:99], v[16:31]
    ds_read_b128 v[64:67], v132 offset:40960
    ds_read_b64_tr_b16 v[68:69], v137 offset:40960
    ds_read_b64_tr_b16 v[70:71], v137 offset:41472
    s_mov_b32 s72, 262144
    s_add_u32 m0, s76, 32768
    s_nop 0
    buffer_load_dwordx4 v142, s[44:47], s72 offen lds
    v_mfma_f32_32x32x16_bf16 v[32:47], v[104:107], v[96:99], v[32:47]
    ds_read_b64_tr_b16 v[72:73], v137 offset:49152
    ds_read_b64_tr_b16 v[74:75], v137 offset:49664
    v_mfma_f32_32x32x16_bf16 v[48:63], v[108:111], v[96:99], v[48:63]
    ds_read_b64_tr_b16 v[76:77], v137 offset:57344
    ds_read_b64_tr_b16 v[78:79], v137 offset:57856
    s_mov_b32 s72, 262144
    s_add_u32 m0, s76, 33792
    s_nop 0
    buffer_load_dwordx4 v143, s[44:47], s72 offen lds
    s_waitcnt lgkmcnt(7)
    v_mfma_f32_32x32x16_bf16 v[16:31], v[116:119], v[112:115], v[16:31]
    ds_read_b128 v[80:83], v133 offset:40960
    ds_read_b64_tr_b16 v[84:85], v137 offset:43008
    ds_read_b64_tr_b16 v[86:87], v137 offset:43520
    v_mfma_f32_32x32x16_bf16 v[32:47], v[120:123], v[112:115], v[32:47]
    ds_read_b64_tr_b16 v[88:89], v137 offset:51200
    ds_read_b64_tr_b16 v[90:91], v137 offset:51712
    s_mov_b32 s72, 393216
    s_add_u32 m0, s76, 49152
    s_nop 0
    buffer_load_dwordx4 v142, s[44:47], s72 offen lds
    v_mfma_f32_32x32x16_bf16 v[48:63], v[124:127], v[112:115], v[48:63]
    ds_read_b64_tr_b16 v[92:93], v137 offset:59392
    ds_read_b64_tr_b16 v[94:95], v137 offset:59904
    s_waitcnt vmcnt(3) lgkmcnt(7)
    v_mfma_f32_32x32x16_bf16 v[16:31], v[68:71], v[64:67], v[16:31]
    ds_read_b128 v[96:99], v134 offset:40960
    ds_read_b64_tr_b16 v[100:101], v137 offset:45056
    ds_read_b64_tr_b16 v[102:103], v137 offset:45568
    s_mov_b32 s72, 393216
    s_add_u32 m0, s76, 50176
    s_nop 0
    buffer_load_dwordx4 v143, s[44:47], s72 offen lds
    v_min3_u32 v4, v147, v149, v151
    v_max3_u32 v5, v147, v149, v151
    v_min3_u32 v4, v4, v153, v155
    v_max3_u32 v5, v5, v153, v155
    v_min3_u32 v4, v4, v157, v159
    v_mfma_f32_32x32x16_bf16 v[32:47], v[72:75], v[64:67], v[32:47]
    ds_read_b64_tr_b16 v[104:105], v137 offset:53248
    ds_read_b64_tr_b16 v[106:107], v137 offset:53760
    v_max3_u32 v5, v5, v157, v159
    v_min3_u32 v4, v4, v161, v163
    v_max3_u32 v5, v5, v161, v163
    v_min3_u32 v4, v4, v165, v167
    v_mfma_f32_32x32x16_bf16 v[48:63], v[76:79], v[64:67], v[48:63]
    ds_read_b64_tr_b16 v[108:109], v137 offset:61440
    ds_read_b64_tr_b16 v[110:111], v137 offset:61952
    s_mov_b32 s72, 786432
    s_add_u32 m0, s76, 65536
    s_nop 0
    buffer_load_dwordx4 v142, s[44:47], s72 offen lds
    v_max3_u32 v5, v5, v165, v167
    v_min3_u32 v4, v4, v169, v171
    v_max3_u32 v5, v5, v169, v171
    v_cmp_ne_u32 s[14:15], s80, v4
    s_waitcnt lgkmcnt(7)
    v_mfma_f32_32x32x16_bf16 v[16:31], v[84:87], v[80:83], v[16:31]
    ds_read_b128 v[112:115], v135 offset:40960
    ds_read_b64_tr_b16 v[116:117], v137 offset:47104
    ds_read_b64_tr_b16 v[118:119], v137 offset:47616
    v_cmp_ne_u32 s[16:17], s80, v5
    v_cmp_eq_u32 vcc, 0, v3
    s_nop 1
    v_cndmask_b32 v172, 0, v144, vcc
    v_cndmask_b32 v173, 0, v144, vcc
    v_mfma_f32_32x32x16_bf16 v[32:47], v[88:91], v[80:83], v[32:47]
    ds_read_b64_tr_b16 v[120:121], v137 offset:55296
    ds_read_b64_tr_b16 v[122:123], v137 offset:55808
    s_mov_b32 s72, 786432
    s_add_u32 m0, s76, 66560
    s_nop 0
    buffer_load_dwordx4 v143, s[44:47], s72 offen lds
    v_cndmask_b32 v174, 0, v145, vcc
    v_add_f32 v148, v148, v150
    v_add_f32 v152, v152, v154
    v_add_f32 v148, v148, v152
    v_mfma_f32_32x32x16_bf16 v[48:63], v[92:95], v[80:83], v[48:63]
    ds_read_b64_tr_b16 v[124:125], v137 offset:63488
    ds_read_b64_tr_b16 v[126:127], v137 offset:64000
    v_add_f32 v156, v156, v158
    v_add_f32 v160, v160, v162
    v_add_f32 v156, v156, v160
    v_add_f32 v164, v164, v166
    s_waitcnt lgkmcnt(7)
    s_barrier
    v_mfma_f32_32x32x16_bf16 v[16:31], v[100:103], v[96:99], v[16:31]
    v_add_f32 v168, v168, v170
    v_add_f32 v164, v164, v168
    v_mov_b32 v150, v148
    v_mov_b32 v158, v156
    v_mov_b32 v166, v164
    s_mov_b32 s72, 917504
    s_add_u32 m0, s76, 81920
    s_nop 0
    buffer_load_dwordx4 v142, s[44:47], s72 offen lds
    v_mfma_f32_32x32x16_bf16 v[32:47], v[104:107], v[96:99], v[32:47]
    v_permlane32_swap_b32 v150, v148
    v_permlane32_swap_b32 v158, v156
    v_permlane32_swap_b32 v166, v164
    v_add_f32 v148, v150, v148
    s_mov_b32 s72, 917504
    s_add_u32 m0, s76, 82944
    s_nop 0
    buffer_load_dwordx4 v143, s[44:47], s72 offen lds
    v_mfma_f32_32x32x16_bf16 v[48:63], v[108:111], v[96:99], v[48:63]
    v_add_f32 v156, v158, v156
    v_add_f32 v164, v166, v164
    v_cvt_pk_bf16_f32 v176, v148, v148
    v_and_b32 v150, 0xffff0000, v176
    s_waitcnt lgkmcnt(0)
    v_mfma_f32_32x32x16_bf16 v[16:31], v[116:119], v[112:115], v[16:31]
    v_sub_f32 v150, v148, v150
    v_cvt_pk_bf16_f32 v177, v150, v150
    v_cvt_pk_bf16_f32 v180, v156, v156
    v_and_b32 v158, 0xffff0000, v180
    s_mov_b32 s72, 1048576
    s_add_u32 m0, s76, 98304
    s_nop 0
    buffer_load_dwordx4 v142, s[44:47], s72 offen lds
    ds_read_b64_tr_b16 v[128:129], v227 offset:0
    ds_read_b64_tr_b16 v[130:131], v227 offset:1024
    ds_read_b64_tr_b16 v[132:133], v228 offset:0
    v_mfma_f32_32x32x16_bf16 v[32:47], v[120:123], v[112:115], v[32:47]
    v_sub_f32 v158, v156, v158
    v_cvt_pk_bf16_f32 v181, v158, v158
    v_cvt_pk_bf16_f32 v184, v164, v164
    v_and_b32 v166, 0xffff0000, v184
    s_mov_b32 s72, 1048576
    s_add_u32 m0, s76, 99328
    s_nop 0
    buffer_load_dwordx4 v143, s[44:47], s72 offen lds
    ds_read_b64_tr_b16 v[134:135], v228 offset:1024
    ds_read_b64_tr_b16 v[136:137], v227 offset:2048
    ds_read_b64_tr_b16 v[138:139], v227 offset:3072
    v_mfma_f32_32x32x16_bf16 v[48:63], v[124:127], v[112:115], v[48:63]
    v_sub_f32 v166, v164, v166
    v_cvt_pk_bf16_f32 v185, v166, v166
    ds_read_b64_tr_b16 v[200:201], v228 offset:2048
    ds_read_b64_tr_b16 v[202:203], v228 offset:3072
    s_mov_b32 s73, 0
ST_30:
    s_or_b64 s[14:15], s[14:15], s[16:17]
    s_cbranch_scc0 ST_30d
    s_add_u32 s73, s73, 1
    s_cmp_gt_u32 s73, 20000
    s_cbranch_scc1 ST_30d
    buffer_load_dwordx4 v[144:147], v210, s[36:39], 0 offen sc1
    s_add_u32 s72, s93, 0
    buffer_load_dwordx4 v[148:151], v211, s[36:39], s72 offen offset:0 sc1
    s_add_u32 s72, s93, 0
    buffer_load_dwordx4 v[152:155], v211, s[36:39], s72 offen offset:1024 sc1
    s_add_u32 s72, s93, 4096
    buffer_load_dwordx4 v[156:159], v211, s[36:39], s72 offen offset:0 sc1
    s_add_u32 s72, s93, 4096
    buffer_load_dwordx4 v[160:163], v211, s[36:39], s72 offen offset:1024 sc1
    s_add_u32 s72, s93, 8192
    buffer_load_dwordx4 v[164:167], v211, s[36:39], s72 offen offset:0 sc1
    s_add_u32 s72, s93, 8192
    buffer_load_dwordx4 v[168:171], v211, s[36:39], s72 offen offset:1024 sc1
    s_waitcnt vmcnt(0)
    v_min3_u32 v4, v147, v149, v151
    v_max3_u32 v5, v147, v149, v151
    v_min3_u32 v4, v4, v153, v155
    v_max3_u32 v5, v5, v153, v155
    v_min3_u32 v4, v4, v157, v159
    v_max3_u32 v5, v5, v157, v159
    v_min3_u32 v4, v4, v161, v163
    v_max3_u32 v5, v5, v161, v163
    v_min3_u32 v4, v4, v165, v167
    v_max3_u32 v5, v5, v165, v167
    v_min3_u32 v4, v4, v169, v171
    v_max3_u32 v5, v5, v169, v171
    v_cmp_ne_u32 s[14:15], s80, v4
    v_cmp_ne_u32 s[16:17], s80, v5
    v_cmp_eq_u32 vcc, 0, v3
    s_nop 1
    v_cndmask_b32 v172, 0, v144, vcc
    v_cndmask_b32 v173, 0, v144, vcc
    v_cndmask_b32 v174, 0, v145, vcc
    v_add_f32 v148, v148, v150
    v_add_f32 v152, v152, v154
    v_add_f32 v148, v148, v152
    v_add_f32 v156, v156, v158
    v_add_f32 v160, v160, v162
    v_add_f32 v156, v156, v160
    v_add_f32 v164, v164, v166
    v_add_f32 v168, v168, v170
    v_add_f32 v164, v164, v168
    v_mov_b32 v150, v148
    v_mov_b32 v158, v156
    v_mov_b32 v166, v164
    v_permlane32_swap_b32 v150, v148
    v_permlane32_swap_b32 v158, v156
    v_permlane32_swap_b32 v166, v164
    v_add_f32 v148, v150, v148
    v_add_f32 v156, v158, v156
    v_add_f32 v164, v166, v164
    v_cvt_pk_bf16_f32 v176, v148, v148
    v_and_b32 v150, 0xffff0000, v176
    v_sub_f32 v150, v148, v150
    v_cvt_pk_bf16_f32 v177, v150, v150
    v_cvt_pk_bf16_f32 v180, v156, v156
    v_and_b32 v158, 0xffff0000, v180
    v_sub_f32 v158, v156, v158
    v_cvt_pk_bf16_f32 v181, v158, v158
    v_cvt_pk_bf16_f32 v184, v164, v164
    v_and_b32 v166, 0xffff0000, v184
    v_sub_f32 v166, v164, v166
    v_cvt_pk_bf16_f32 v185, v166, v166
    s_nop 4
    s_branch ST_30
ST_30d:
    v_mfma_f32_32x32x16_bf16 v[16:31], v[176:179], v[172:175], v[16:31]
    v_mfma_f32_32x32x16_bf16 v[32:47], v[180:183], v[172:175], v[32:47]
    v_mfma_f32_32x32x16_bf16 v[48:63], v[184:187], v[172:175], v[48:63]
    v_rcp_f32 v14, v146
    v_mul_f32 v12, 0xc0135761, v146
    v_mul_f32 v10, v146, v146
    v_mul_f32 v10, v10, v12
    v_mul_f32 v10, 0x3d372713, v10
    s_nop 4
    v_pk_mul_f32 v[96:97], v[16:17], v[16:17]
    v_pk_mul_f32 v[98:99], v[18:19], v[18:19]
    v_pk_mul_f32 v[100:101], v[20:21], v[20:21]
    v_pk_mul_f32 v[102:103], v[22:23], v[22:23]
    v_pk_mul_f32 v[104:105], v[24:25], v[24:25]
    v_pk_mul_f32 v[106:107], v[26:27], v[26:27]
    v_pk_mul_f32 v[108:109], v[28:29], v[28:29]
    v_pk_mul_f32 v[110:111], v[30:31], v[30:31]
    v_pk_fma_f32 v[96:97], v[96:97], v[10:11], v[12:13] op_sel_hi:[1,0,0]
    v_pk_fma_f32 v[98:99], v[98:99], v[10:11], v[12:13] op_sel_hi:[1,0,0]
    v_pk_fma_f32 v[100:101], v[100:101], v[10:11], v[12:13] op_sel_hi:[1,0,0]
    v_pk_fma_f32 v[102:103], v[102:103], v[10:11], v[12:13] op_sel_hi:[1,0,0]
    v_pk_fma_f32 v[104:105], v[104:105], v[10:11], v[12:13] op_sel_hi:[1,0,0]
    v_pk_fma_f32 v[106:107], v[106:107], v[10:11], v[12:13] op_sel_hi:[1,0,0]
    v_pk_fma_f32 v[108:109], v[108:109], v[10:11], v[12:13] op_sel_hi:[1,0,0]
    v_pk_fma_f32 v[110:111], v[110:111], v[10:11], v[12:13] op_sel_hi:[1,0,0]
    v_pk_mul_f32 v[96:97], v[96:97], v[16:17]
    v_pk_mul_f32 v[98:99], v[98:99], v[18:19]
    v_pk_mul_f32 v[100:101], v[100:101], v[20:21]
    v_pk_mul_f32 v[102:103], v[102:103], v[22:23]
    v_pk_mul_f32 v[104:105], v[104:105], v[24:25]
    v_pk_mul_f32 v[106:107], v[106:107], v[26:27]
    v_pk_mul_f32 v[108:109], v[108:109], v[28:29]
    v_pk_mul_f32 v[110:111], v[110:111], v[30:31]
    v_exp_f32 v96, v96
    v_exp_f32 v97, v97
    v_exp_f32 v98, v98
    v_exp_f32 v99, v99
    v_exp_f32 v100, v100
    v_exp_f32 v101, v101
    v_exp_f32 v102, v102
    v_exp_f32 v103, v103
    v_exp_f32 v104, v104
    v_exp_f32 v105, v105
    v_exp_f32 v106, v106
    v_exp_f32 v107, v107
    v_exp_f32 v108, v108
    v_exp_f32 v109, v109
    v_exp_f32 v110, v110
    v_exp_f32 v111, v111
    v_pk_fma_f32 v[96:97], v[96:97], v[14:15], v[14:15] op_sel_hi:[1,0,0]
    v_pk_fma_f32 v[98:99], v[98:99], v[14:15], v[14:15] op_sel_hi:[1,0,0]
    v_pk_fma_f32 v[100:101], v[100:101], v[14:15], v[14:15] op_sel_hi:[1,0,0]
    v_pk_fma_f32 v[102:103], v[102:103], v[14:15], v[14:15] op_sel_hi:[1,0,0]
    v_pk_fma_f32 v[104:105], v[104:105], v[14:15], v[14:15] op_sel_hi:[1,0,0]
    v_pk_fma_f32 v[106:107], v[106:107], v[14:15], v[14:15] op_sel_hi:[1,0,0]
    v_pk_fma_f32 v[108:109], v[108:109], v[14:15], v[14:15] op_sel_hi:[1,0,0]
    v_pk_fma_f32 v[110:111], v[110:111], v[14:15], v[14:15] op_sel_hi:[1,0,0]
    v_rcp_f32 v96, v96
    v_rcp_f32 v97, v97
    v_rcp_f32 v98, v98
    v_rcp_f32 v99, v99
    v_rcp_f32 v100, v100
    v_rcp_f32 v101, v101
    v_rcp_f32 v102, v102
    v_rcp_f32 v103, v103
    v_rcp_f32 v104, v104
    v_rcp_f32 v105, v105
    v_rcp_f32 v106, v106
    v_rcp_f32 v107, v107
    v_rcp_f32 v108, v108
    v_rcp_f32 v109, v109
    v_rcp_f32 v110, v110
    v_rcp_f32 v111, v111
    v_pk_mul_f32 v[16:17], v[16:17], v[96:97]
    v_cvt_pk_bf16_f32 v64, v16, v17
    v_pk_mul_f32 v[18:19], v[18:19], v[98:99]
    v_cvt_pk_bf16_f32 v65, v18, v19
    v_pk_mul_f32 v[20:21], v[20:21], v[100:101]
    v_cvt_pk_bf16_f32 v66, v20, v21
    v_pk_mul_f32 v[22:23], v[22:23], v[102:103]
    v_cvt_pk_bf16_f32 v67, v22, v23
    v_pk_mul_f32 v[24:25], v[24:25], v[104:105]
    v_cvt_pk_bf16_f32 v68, v24, v25
    v_pk_mul_f32 v[26:27], v[26:27], v[106:107]
    v_cvt_pk_bf16_f32 v69, v26, v27
    v_pk_mul_f32 v[28:29], v[28:29], v[108:109]
    v_cvt_pk_bf16_f32 v70, v28, v29
    v_pk_mul_f32 v[30:31], v[30:31], v[110:111]
    v_cvt_pk_bf16_f32 v71, v30, v31
    buffer_store_dwordx4 v[64:67], v226, s[36:39], s10 offen offset:0 sc1
    buffer_store_dwordx4 v[68:71], v226, s[36:39], s10 offen offset:1024 sc1
    v_pk_mul_f32 v[96:97], v[32:33], v[32:33]
    v_pk_mul_f32 v[98:99], v[34:35], v[34:35]
    v_pk_mul_f32 v[100:101], v[36:37], v[36:37]
    v_pk_mul_f32 v[102:103], v[38:39], v[38:39]
    v_pk_mul_f32 v[104:105], v[40:41], v[40:41]
    v_pk_mul_f32 v[106:107], v[42:43], v[42:43]
    v_pk_mul_f32 v[108:109], v[44:45], v[44:45]
    v_pk_mul_f32 v[110:111], v[46:47], v[46:47]
    v_pk_fma_f32 v[96:97], v[96:97], v[10:11], v[12:13] op_sel_hi:[1,0,0]
    v_pk_fma_f32 v[98:99], v[98:99], v[10:11], v[12:13] op_sel_hi:[1,0,0]
    v_pk_fma_f32 v[100:101], v[100:101], v[10:11], v[12:13] op_sel_hi:[1,0,0]
    v_pk_fma_f32 v[102:103], v[102:103], v[10:11], v[12:13] op_sel_hi:[1,0,0]
    v_pk_fma_f32 v[104:105], v[104:105], v[10:11], v[12:13] op_sel_hi:[1,0,0]
    v_pk_fma_f32 v[106:107], v[106:107], v[10:11], v[12:13] op_sel_hi:[1,0,0]
    v_pk_fma_f32 v[108:109], v[108:109], v[10:11], v[12:13] op_sel_hi:[1,0,0]
    v_pk_fma_f32 v[110:111], v[110:111], v[10:11], v[12:13] op_sel_hi:[1,0,0]
    v_pk_mul_f32 v[96:97], v[96:97], v[32:33]
    v_pk_mul_f32 v[98:99], v[98:99], v[34:35]
    v_pk_mul_f32 v[100:101], v[100:101], v[36:37]
    v_pk_mul_f32 v[102:103], v[102:103], v[38:39]
    v_pk_mul_f32 v[104:105], v[104:105], v[40:41]
    v_pk_mul_f32 v[106:107], v[106:107], v[42:43]
    v_pk_mul_f32 v[108:109], v[108:109], v[44:45]
    v_pk_mul_f32 v[110:111], v[110:111], v[46:47]
    v_exp_f32 v96, v96
    v_exp_f32 v97, v97
    v_exp_f32 v98, v98
    v_exp_f32 v99, v99
    v_exp_f32 v100, v100
    v_exp_f32 v101, v101
    v_exp_f32 v102, v102
    v_exp_f32 v103, v103
    v_exp_f32 v104, v104
    v_exp_f32 v105, v105
    v_exp_f32 v106, v106
    v_exp_f32 v107, v107
    v_exp_f32 v108, v108
    v_exp_f32 v109, v109
    v_exp_f32 v110, v110
    v_exp_f32 v111, v111
    v_pk_fma_f32 v[96:97], v[96:97], v[14:15], v[14:15] op_sel_hi:[1,0,0]
    v_pk_fma_f32 v[98:99], v[98:99], v[14:15], v[14:15] op_sel_hi:[1,0,0]
    v_pk_fma_f32 v[100:101], v[100:101], v[14:15], v[14:15] op_sel_hi:[1,0,0]
    v_pk_fma_f32 v[102:103], v[102:103], v[14:15], v[14:15] op_sel_hi:[1,0,0]
    v_pk_fma_f32 v[104:105], v[104:105], v[14:15], v[14:15] op_sel_hi:[1,0,0]
    v_pk_fma_f32 v[106:107], v[106:107], v[14:15], v[14:15] op_sel_hi:[1,0,0]
    v_pk_fma_f32 v[108:109], v[108:109], v[14:15], v[14:15] op_sel_hi:[1,0,0]
    v_pk_fma_f32 v[110:111], v[110:111], v[14:15], v[14:15] op_sel_hi:[1,0,0]
    v_rcp_f32 v96, v96
    v_rcp_f32 v97, v97
    v_rcp_f32 v98, v98
    v_rcp_f32 v99, v99
    v_rcp_f32 v100, v100
    v_rcp_f32 v101, v101
    v_rcp_f32 v102, v102
    v_rcp_f32 v103, v103
    v_rcp_f32 v104, v104
    v_rcp_f32 v105, v105
    v_rcp_f32 v106, v106
    v_rcp_f32 v107, v107
    v_rcp_f32 v108, v108
    v_rcp_f32 v109, v109
    v_rcp_f32 v110, v110
    v_rcp_f32 v111, v111
    v_pk_mul_f32 v[32:33], v[32:33], v[96:97]
    v_cvt_pk_bf16_f32 v72, v32, v33
    v_pk_mul_f32 v[34:35], v[34:35], v[98:99]
    v_cvt_pk_bf16_f32 v73, v34, v35
    v_pk_mul_f32 v[36:37], v[36:37], v[100:101]
    v_cvt_pk_bf16_f32 v74, v36, v37
    v_pk_mul_f32 v[38:39], v[38:39], v[102:103]
    v_cvt_pk_bf16_f32 v75, v38, v39
    v_pk_mul_f32 v[40:41], v[40:41], v[104:105]
    v_cvt_pk_bf16_f32 v76, v40, v41
    v_pk_mul_f32 v[42:43], v[42:43], v[106:107]
    v_cvt_pk_bf16_f32 v77, v42, v43
    v_pk_mul_f32 v[44:45], v[44:45], v[108:109]
    v_cvt_pk_bf16_f32 v78, v44, v45
    v_pk_mul_f32 v[46:47], v[46:47], v[110:111]
    v_cvt_pk_bf16_f32 v79, v46, v47
    buffer_store_dwordx4 v[72:75], v226, s[36:39], s22 offen offset:0 sc1
    buffer_store_dwordx4 v[76:79], v226, s[36:39], s22 offen offset:1024 sc1
    v_pk_mul_f32 v[96:97], v[48:49], v[48:49]
    v_pk_mul_f32 v[98:99], v[50:51], v[50:51]
    v_pk_mul_f32 v[100:101], v[52:53], v[52:53]
    v_pk_mul_f32 v[102:103], v[54:55], v[54:55]
    v_pk_mul_f32 v[104:105], v[56:57], v[56:57]
    v_pk_mul_f32 v[106:107], v[58:59], v[58:59]
    v_pk_mul_f32 v[108:109], v[60:61], v[60:61]
    v_pk_mul_f32 v[110:111], v[62:63], v[62:63]
    v_pk_fma_f32 v[96:97], v[96:97], v[10:11], v[12:13] op_sel_hi:[1,0,0]
    v_pk_fma_f32 v[98:99], v[98:99], v[10:11], v[12:13] op_sel_hi:[1,0,0]
    v_pk_fma_f32 v[100:101], v[100:101], v[10:11], v[12:13] op_sel_hi:[1,0,0]
    v_pk_fma_f32 v[102:103], v[102:103], v[10:11], v[12:13] op_sel_hi:[1,0,0]
    v_pk_fma_f32 v[104:105], v[104:105], v[10:11], v[12:13] op_sel_hi:[1,0,0]
    v_pk_fma_f32 v[106:107], v[106:107], v[10:11], v[12:13] op_sel_hi:[1,0,0]
    v_pk_fma_f32 v[108:109], v[108:109], v[10:11], v[12:13] op_sel_hi:[1,0,0]
    v_pk_fma_f32 v[110:111], v[110:111], v[10:11], v[12:13] op_sel_hi:[1,0,0]
    v_pk_mul_f32 v[96:97], v[96:97], v[48:49]
    v_pk_mul_f32 v[98:99], v[98:99], v[50:51]
    v_pk_mul_f32 v[100:101], v[100:101], v[52:53]
    v_pk_mul_f32 v[102:103], v[102:103], v[54:55]
    v_pk_mul_f32 v[104:105], v[104:105], v[56:57]
    v_pk_mul_f32 v[106:107], v[106:107], v[58:59]
    v_pk_mul_f32 v[108:109], v[108:109], v[60:61]
    v_pk_mul_f32 v[110:111], v[110:111], v[62:63]
    v_exp_f32 v96, v96
    v_exp_f32 v97, v97
    v_exp_f32 v98, v98
    v_exp_f32 v99, v99
    v_exp_f32 v100, v100
    v_exp_f32 v101, v101
    v_exp_f32 v102, v102
    v_exp_f32 v103, v103
    v_exp_f32 v104, v104
    v_exp_f32 v105, v105
    v_exp_f32 v106, v106
    v_exp_f32 v107, v107
    v_exp_f32 v108, v108
    v_exp_f32 v109, v109
    v_exp_f32 v110, v110
    v_exp_f32 v111, v111
    v_pk_fma_f32 v[96:97], v[96:97], v[14:15], v[14:15] op_sel_hi:[1,0,0]
    v_pk_fma_f32 v[98:99], v[98:99], v[14:15], v[14:15] op_sel_hi:[1,0,0]
    v_pk_fma_f32 v[100:101], v[100:101], v[14:15], v[14:15] op_sel_hi:[1,0,0]
    v_pk_fma_f32 v[102:103], v[102:103], v[14:15], v[14:15] op_sel_hi:[1,0,0]
    v_pk_fma_f32 v[104:105], v[104:105], v[14:15], v[14:15] op_sel_hi:[1,0,0]
    v_pk_fma_f32 v[106:107], v[106:107], v[14:15], v[14:15] op_sel_hi:[1,0,0]
    v_pk_fma_f32 v[108:109], v[108:109], v[14:15], v[14:15] op_sel_hi:[1,0,0]
    v_pk_fma_f32 v[110:111], v[110:111], v[14:15], v[14:15] op_sel_hi:[1,0,0]
    v_rcp_f32 v96, v96
    v_rcp_f32 v97, v97
    v_rcp_f32 v98, v98
    v_rcp_f32 v99, v99
    v_rcp_f32 v100, v100
    v_rcp_f32 v101, v101
    v_rcp_f32 v102, v102
    v_rcp_f32 v103, v103
    v_rcp_f32 v104, v104
    v_rcp_f32 v105, v105
    v_rcp_f32 v106, v106
    v_rcp_f32 v107, v107
    v_rcp_f32 v108, v108
    v_rcp_f32 v109, v109
    v_rcp_f32 v110, v110
    v_rcp_f32 v111, v111
    v_pk_mul_f32 v[48:49], v[48:49], v[96:97]
    v_cvt_pk_bf16_f32 v80, v48, v49
    v_pk_mul_f32 v[50:51], v[50:51], v[98:99]
    v_cvt_pk_bf16_f32 v81, v50, v51
    v_pk_mul_f32 v[52:53], v[52:53], v[100:101]
    v_cvt_pk_bf16_f32 v82, v52, v53
    v_pk_mul_f32 v[54:55], v[54:55], v[102:103]
    v_cvt_pk_bf16_f32 v83, v54, v55
    v_pk_mul_f32 v[56:57], v[56:57], v[104:105]
    v_cvt_pk_bf16_f32 v84, v56, v57
    v_pk_mul_f32 v[58:59], v[58:59], v[106:107]
    v_cvt_pk_bf16_f32 v85, v58, v59
    v_pk_mul_f32 v[60:61], v[60:61], v[108:109]
    v_cvt_pk_bf16_f32 v86, v60, v61
    v_pk_mul_f32 v[62:63], v[62:63], v[110:111]
    v_cvt_pk_bf16_f32 v87, v62, v63
    buffer_store_dwordx4 v[80:83], v226, s[36:39], s20 offen offset:0 sc1
    buffer_store_dwordx4 v[84:87], v226, s[36:39], s21 offen offset:0 sc1
    s_waitcnt lgkmcnt(0)
    s_waitcnt vmcnt(0)
    s_barrier
    s_cmp_eq_u32 s64, 0
    s_cselect_b32 s72, s6, 1073741824
    v_mov_b32 v14, s80
    buffer_store_dword v14, v198, s[36:39], s72 offen sc1
    s_mov_b32 s72, 524288
    s_add_u32 m0, s76, 131072
    s_nop 0
    buffer_load_dwordx4 v142, s[44:47], s72 offen lds
    s_mov_b32 s72, 524288
    s_add_u32 m0, s76, 132096
    s_nop 0
    buffer_load_dwordx4 v143, s[44:47], s72 offen lds
    s_mov_b32 s72, 655360
    s_add_u32 m0, s76, 147456
    s_nop 0
    buffer_load_dwordx4 v142, s[44:47], s72 offen lds
    s_mov_b32 s72, 655360
    s_add_u32 m0, s76, 148480
    s_nop 0
    buffer_load_dwordx4 v143, s[44:47], s72 offen lds
    s_mov_b32 s72, 1179648
    s_add_u32 m0, s76, 0
    s_nop 0
    buffer_load_dwordx4 v142, s[44:47], s72 offen lds
    s_mov_b32 s72, 1179648
    s_add_u32 m0, s76, 1024
    s_nop 0
    buffer_load_dwordx4 v143, s[44:47], s72 offen lds
    s_cmp_ge_u32 s64, 6
    s_mov_b32 s72, 1310720
    s_cmov_b32 s72, 1277952
    s_mov_b32 s73, 118784
    s_cmov_b32 s73, 114688
    s_add_u32 m0, s76, s73
    s_nop 0
    buffer_load_dwordx4 v142, s[44:47], s72 offen lds
    s_cmp_ge_u32 s64, 6
    s_mov_b32 s72, 1310720
    s_cmov_b32 s72, 1277952
    s_mov_b32 s73, 119808
    s_cmov_b32 s73, 115712
    s_add_u32 m0, s76, s73
    s_nop 0
    buffer_load_dwordx4 v143, s[44:47], s72 offen lds
    s_cmp_lg_u32 s64, 0
    s_cbranch_scc1 PL_31d
    s_mov_b64 exec, 16711680
    s_mov_b32 s73, 0
    s_mov_b32 s72, 0
PL_31:
    buffer_load_dword v15, v197, s[36:39], s72 offen sc1
    s_waitcnt vmcnt(0)
    v_cmp_ne_u32 vcc, s80, v15
    s_add_u32 s73, s73, 1
    s_cmp_gt_u32 s73, 20000
    s_cbranch_scc1 PL_31x
    s_cbranch_vccnz PL_31
PL_31x:
    s_mov_b64 exec, -1
PL_31d:
    s_barrier
    s_add_u32 s72, s11, 0
    buffer_load_dwordx4 v[56:59], v226, s[36:39], s72 offen offset:0 sc1
    s_add_u32 s72, s11, 0
    buffer_load_dwordx4 v[60:63], v226, s[36:39], s72 offen offset:1024 sc1
    s_add_u32 s72, s11, 8192
    buffer_load_dwordx4 v[96:99], v226, s[36:39], s72 offen offset:0 sc1
    s_add_u32 s72, s11, 8192
    buffer_load_dwordx4 v[100:103], v226, s[36:39], s72 offen offset:1024 sc1
    s_add_u32 s72, s11, 16384
    buffer_load_dwordx4 v[104:107], v226, s[36:39], s72 offen offset:0 sc1
    s_add_u32 s72, s11, 16384
    buffer_load_dwordx4 v[108:111], v226, s[36:39], s72 offen offset:1024 sc1
    s_add_u32 s72, s11, 24576
    buffer_load_dwordx4 v[112:115], v226, s[36:39], s72 offen offset:0 sc1
    s_add_u32 s72, s11, 24576
    buffer_load_dwordx4 v[116:119], v226, s[36:39], s72 offen offset:1024 sc1
    s_add_u32 s72, s11, 32768
    buffer_load_dwordx4 v[120:123], v226, s[36:39], s72 offen offset:0 sc1
    s_add_u32 s72, s11, 32768
    buffer_load_dwordx4 v[124:127], v226, s[36:39], s72 offen offset:1024 sc1
    s_add_u32 s72, s11, 40960
    buffer_load_dwordx4 v[144:147], v226, s[36:39], s72 offen offset:0 sc1
    s_add_u32 s72, s11, 40960
    buffer_load_dwordx4 v[164:167], v226, s[36:39], s72 offen offset:1024 sc1
    s_add_u32 s72, s11, 49152
    buffer_load_dwordx4 v[168:171], v226, s[36:39], s72 offen offset:0 sc1
    s_add_u32 s72, s11, 49152
    buffer_load_dwordx4 v[172:175], v226, s[36:39], s72 offen offset:1024 sc1
    s_add_u32 s72, s11, 57344
    buffer_load_dwordx4 v[176:179], v226, s[36:39], s72 offen offset:0 sc1
    s_add_u32 s72, s11, 57344
    buffer_load_dwordx4 v[180:183], v226, s[36:39], s72 offen offset:1024 sc1
    s_add_u32 s72, s11, 65536
    buffer_load_dwordx4 v[184:187], v226, s[36:39], s72 offen offset:0 sc1
    s_add_u32 s72, s11, 65536
    buffer_load_dwordx4 v[188:191], v226, s[36:39], s72 offen offset:1024 sc1
    s_add_u32 s72, s11, 73728
    buffer_load_dwordx4 v[192:195], v226, s[36:39], s72 offen offset:0 sc1
    s_add_u32 s72, s11, 73728
    buffer_load_dwordx4 v[204:207], v226, s[36:39], s72 offen offset:1024 sc1
    s_add_u32 s72, s11, 81920
    buffer_load_dwordx4 v[208:211], v226, s[36:39], s72 offen offset:0 sc1
    s_add_u32 s72, s11, 81920
    buffer_load_dwordx4 v[212:215], v226, s[36:39], s72 offen offset:1024 sc1
    s_waitcnt vmcnt(20) lgkmcnt(0)
    v_mfma_f32_32x32x16_bf16 v[16:31], v[128:131], v[56:59], 0
    ds_read_b64_tr_b16 v[64:65], v227 offset:16384
    ds_read_b64_tr_b16 v[66:67], v227 offset:17408
    v_mfma_f32_32x32x16_bf16 v[32:47], v[132:135], v[56:59], 0
    ds_read_b64_tr_b16 v[68:69], v228 offset:16384
    ds_read_b64_tr_b16 v[70:71], v228 offset:17408
    v_mfma_f32_32x32x16_bf16 v[16:31], v[136:139], v[60:63], v[16:31]
    ds_read_b64_tr_b16 v[72:73], v227 offset:18432
    ds_read_b64_tr_b16 v[74:75], v227 offset:19456
    v_mfma_f32_32x32x16_bf16 v[32:47], v[200:203], v[60:63], v[32:47]
    ds_read_b64_tr_b16 v[76:77], v228 offset:18432
    ds_read_b64_tr_b16 v[78:79], v228 offset:19456
    s_waitcnt vmcnt(18) lgkmcnt(0)
    v_mfma_f32_32x32x16_bf16 v[16:31], v[64:67], v[96:99], v[16:31]
    ds_read_b64_tr_b16 v[128:129], v227 offset:32768
    ds_read_b64_tr_b16 v[130:131], v227 offset:33792
    v_mfma_f32_32x32x16_bf16 v[32:47], v[68:71], v[96:99], v[32:47]
    ds_read_b64_tr_b16 v[132:133], v228 offset:32768
    ds_read_b64_tr_b16 v[134:135], v228 offset:33792
    v_mfma_f32_32x32x16_bf16 v[16:31], v[72:75], v[100:103], v[16:31]
    ds_read_b64_tr_b16 v[136:137], v227 offset:34816
    ds_read_b64_tr_b16 v[138:139], v227 offset:35840
    v_mfma_f32_32x32x16_bf16 v[32:47], v[76:79], v[100:103], v[32:47]
    ds_read_b64_tr_b16 v[200:201], v228 offset:34816
    ds_read_b64_tr_b16 v[202:203], v228 offset:35840
    s_waitcnt vmcnt(16) lgkmcnt(0)
    v_mfma_f32_32x32x16_bf16 v[16:31], v[128:131], v[104:107], v[16:31]
    ds_read_b64_tr_b16 v[64:65], v227 offset:49152
    ds_read_b64_tr_b16 v[66:67], v227 offset:50176
    v_mfma_f32_32x32x16_bf16 v[32:47], v[132:135], v[104:107], v[32:47]
    ds_read_b64_tr_b16 v[68:69], v228 offset:49152
    ds_read_b64_tr_b16 v[70:71], v228 offset:50176
    v_mfma_f32_32x32x16_bf16 v[16:31], v[136:139], v[108:111], v[16:31]
    ds_read_b64_tr_b16 v[72:73], v227 offset:51200
    ds_read_b64_tr_b16 v[74:75], v227 offset:52224
    v_mfma_f32_32x32x16_bf16 v[32:47], v[200:203], v[108:111], v[32:47]
    ds_read_b64_tr_b16 v[76:77], v228 offset:51200
    ds_read_b64_tr_b16 v[78:79], v228 offset:52224
    s_waitcnt vmcnt(14) lgkmcnt(0)
    s_barrier
    v_mfma_f32_32x32x16_bf16 v[16:31], v[64:67], v[112:115], v[16:31]
    v_add_u32 v12, 131072, v227
    v_add_u32 v13, 131072, v228
    ds_read_b64_tr_b16 v[128:129], v12 offset:0
    ds_read_b64_tr_b16 v[130:131], v12 offset:1024
    v_mfma_f32_32x32x16_bf16 v[32:47], v[68:71], v[112:115], v[32:47]
    ds_read_b64_tr_b16 v[132:133], v13 offset:0
    ds_read_b64_tr_b16 v[134:135], v13 offset:1024
    v_mfma_f32_32x32x16_bf16 v[16:31], v[72:75], v[116:119], v[16:31]
    ds_read_b64_tr_b16 v[136:137], v12 offset:2048
    ds_read_b64_tr_b16 v[138:139], v12 offset:3072
    v_mfma_f32_32x32x16_bf16 v[32:47], v[76:79], v[116:119], v[32:47]
    ds_read_b64_tr_b16 v[200:201], v13 offset:2048
    ds_read_b64_tr_b16 v[202:203], v13 offset:3072
    s_waitcnt vmcnt(12) lgkmcnt(0)
    v_mfma_f32_32x32x16_bf16 v[16:31], v[128:131], v[120:123], v[16:31]
    v_add_u32 v12, 147456, v227
    v_add_u32 v13, 147456, v228
    ds_read_b64_tr_b16 v[64:65], v12 offset:0
    ds_read_b64_tr_b16 v[66:67], v12 offset:1024
    v_mfma_f32_32x32x16_bf16 v[32:47], v[132:135], v[120:123], v[32:47]
    ds_read_b64_tr_b16 v[68:69], v13 offset:0
    ds_read_b64_tr_b16 v[70:71], v13 offset:1024
    v_mfma_f32_32x32x16_bf16 v[16:31], v[136:139], v[124:127], v[16:31]
    ds_read_b64_tr_b16 v[72:73], v12 offset:2048
    ds_read_b64_tr_b16 v[74:75], v12 offset:3072
    v_mfma_f32_32x32x16_bf16 v[32:47], v[200:203], v[124:127], v[32:47]
    ds_read_b64_tr_b16 v[76:77], v13 offset:2048
    ds_read_b64_tr_b16 v[78:79], v13 offset:3072
    s_waitcnt vmcnt(10) lgkmcnt(0)
    s_barrier
    v_mfma_f32_32x32x16_bf16 v[16:31], v[64:67], v[144:147], v[16:31]
    v_add_u32 v12, 65536, v227
    v_add_u32 v13, 65536, v228
    ds_read_b64_tr_b16 v[128:129], v12 offset:0
    ds_read_b64_tr_b16 v[130:131], v12 offset:1024
    v_mfma_f32_32x32x16_bf16 v[32:47], v[68:71], v[144:147], v[32:47]
    ds_read_b64_tr_b16 v[132:133], v13 offset:0
    ds_read_b64_tr_b16 v[134:135], v13 offset:1024
    s_mov_b32 s72, 0
    s_add_u32 m0, s76, 16384
    s_nop 0
    buffer_load_dwordx4 v142, s[48:51], s72 offen lds
    v_mfma_f32_32x32x16_bf16 v[16:31], v[72:75], v[164:167], v[16:31]
    ds_read_b64_tr_b16 v[136:137], v12 offset:2048
    ds_read_b64_tr_b16 v[138:139], v12 offset:3072
    ds_read_b64_tr_b16 v[200:201], v13 offset:2048
    v_mfma_f32_32x32x16_bf16 v[32:47], v[76:79], v[164:167], v[32:47]
    ds_read_b64_tr_b16 v[202:203], v13 offset:3072
    s_mov_b32 s72, 0
    s_add_u32 m0, s76, 17408
    s_nop 0
    buffer_load_dwordx4 v143, s[48:51], s72 offen lds
    s_waitcnt vmcnt(10) lgkmcnt(0)
    v_mfma_f32_32x32x16_bf16 v[16:31], v[128:131], v[168:171], v[16:31]
    v_add_u32 v12, 81920, v227
    v_add_u32 v13, 81920, v228
    ds_read_b64_tr_b16 v[64:65], v12 offset:0
    ds_read_b64_tr_b16 v[66:67], v12 offset:1024
    v_mfma_f32_32x32x16_bf16 v[32:47], v[132:135], v[168:171], v[32:47]
    ds_read_b64_tr_b16 v[68:69], v13 offset:0
    ds_read_b64_tr_b16 v[70:71], v13 offset:1024
    s_mov_b32 s72, 131072
    s_add_u32 m0, s76, 32768
    s_nop 0
    buffer_load_dwordx4 v142, s[48:51], s72 offen lds
    v_mfma_f32_32x32x16_bf16 v[16:31], v[136:139], v[172:175], v[16:31]
    ds_read_b64_tr_b16 v[72:73], v12 offset:2048
    ds_read_b64_tr_b16 v[74:75], v12 offset:3072
    ds_read_b64_tr_b16 v[76:77], v13 offset:2048
    v_mfma_f32_32x32x16_bf16 v[32:47], v[200:203], v[172:175], v[32:47]
    ds_read_b64_tr_b16 v[78:79], v13 offset:3072
    s_mov_b32 s72, 131072
    s_add_u32 m0, s76, 33792
    s_nop 0
    buffer_load_dwordx4 v143, s[48:51], s72 offen lds
    s_waitcnt vmcnt(10) lgkmcnt(0)
    v_mfma_f32_32x32x16_bf16 v[16:31], v[64:67], v[176:179], v[16:31]
    v_add_u32 v12, 98304, v227
    v_add_u32 v13, 98304, v228
    ds_read_b64_tr_b16 v[128:129], v12 offset:0
    ds_read_b64_tr_b16 v[130:131], v12 offset:1024
    v_mfma_f32_32x32x16_bf16 v[32:47], v[68:71], v[176:179], v[32:47]
    ds_read_b64_tr_b16 v[132:133], v13 offset:0
    ds_read_b64_tr_b16 v[134:135], v13 offset:1024
    s_mov_b32 s72, 262144
    s_add_u32 m0, s76, 49152
    s_nop 0
    buffer_load_dwordx4 v142, s[48:51], s72 offen lds
    v_mfma_f32_32x32x16_bf16 v[16:31], v[72:75], v[180:183], v[16:31]
    ds_read_b64_tr_b16 v[136:137], v12 offset:2048
    ds_read_b64_tr_b16 v[138:139], v12 offset:3072
    ds_read_b64_tr_b16 v[200:201], v13 offset:2048
    v_mfma_f32_32x32x16_bf16 v[32:47], v[76:79], v[180:183], v[32:47]
    ds_read_b64_tr_b16 v[202:203], v13 offset:3072
    s_mov_b32 s72, 262144
    s_add_u32 m0, s76, 50176
    s_nop 0
    buffer_load_dwordx4 v143, s[48:51], s72 offen lds
    s_waitcnt vmcnt(10) lgkmcnt(0)
    s_barrier
    v_mfma_f32_32x32x16_bf16 v[16:31], v[128:131], v[184:187], v[16:31]
    ds_read_b64_tr_b16 v[64:65], v227 offset:0
    ds_read_b64_tr_b16 v[66:67], v227 offset:1024
    ds_read_b64_tr_b16 v[68:69], v228 offset:0
    v_mfma_f32_32x32x16_bf16 v[32:47], v[132:135], v[184:187], v[32:47]
    ds_read_b64_tr_b16 v[70:71], v228 offset:1024
    ds_read_b64_tr_b16 v[72:73], v227 offset:2048
    s_mov_b32 s72, 393216
    s_add_u32 m0, s76, 131072
    s_nop 0
    buffer_load_dwordx4 v142, s[48:51], s72 offen lds
    v_mfma_f32_32x32x16_bf16 v[16:31], v[136:139], v[188:191], v[16:31]
    ds_read_b64_tr_b16 v[74:75], v227 offset:3072
    ds_read_b64_tr_b16 v[76:77], v228 offset:2048
    v_mfma_f32_32x32x16_bf16 v[32:47], v[200:203], v[188:191], v[32:47]
    ds_read_b64_tr_b16 v[78:79], v228 offset:3072
    s_mov_b32 s72, 393216
    s_add_u32 m0, s76, 132096
    s_nop 0
    buffer_load_dwordx4 v143, s[48:51], s72 offen lds
    s_waitcnt vmcnt(10) lgkmcnt(0)
    s_mov_b32 s72, 4096
    buffer_load_dword v15, v197, s[36:39], s72 offen sc1
    v_mfma_f32_32x32x16_bf16 v[16:31], v[64:67], v[192:195], v[16:31]
    v_add_u32 v12, 118784, v227
    v_add_u32 v13, 118784, v228
    ds_read_b64_tr_b16 v[128:129], v12 offset:0
    ds_read_b64_tr_b16 v[130:131], v12 offset:1024
    v_mfma_f32_32x32x16_bf16 v[32:47], v[68:71], v[192:195], v[32:47]
    ds_read_b64_tr_b16 v[132:133], v13 offset:0
    ds_read_b64_tr_b16 v[134:135], v13 offset:1024
    v_mfma_f32_32x32x16_bf16 v[16:31], v[72:75], v[204:207], v[16:31]
    ds_read_b64_tr_b16 v[136:137], v12 offset:2048
    ds_read_b64_tr_b16 v[138:139], v12 offset:3072
    v_mfma_f32_32x32x16_bf16 v[32:47], v[76:79], v[204:207], v[32:47]
    ds_read_b64_tr_b16 v[200:201], v13 offset:2048
    ds_read_b64_tr_b16 v[202:203], v13 offset:3072
    s_waitcnt vmcnt(9) lgkmcnt(0)
    s_cmp_eq_u32 s65, 3
    s_cbranch_scc1 L_skip101
    v_mfma_f32_32x32x16_bf16 v[16:31], v[128:131], v[208:211], v[16:31]
    v_mfma_f32_32x32x16_bf16 v[32:47], v[132:135], v[208:211], v[32:47]
    v_mfma_f32_32x32x16_bf16 v[16:31], v[136:139], v[212:215], v[16:31]
    v_mfma_f32_32x32x16_bf16 v[32:47], v[200:203], v[212:215], v[32:47]
L_skip101:
    s_nop 7
    s_nop 2
    v_pk_add_f32 v[16:17], v[16:17], v[244:245]
    v_pk_add_f32 v[18:19], v[18:19], v[246:247]
    v_pk_add_f32 v[20:21], v[20:21], v[248:249]
    v_pk_add_f32 v[22:23], v[22:23], v[250:251]
L_p2:
    s_waitcnt vmcnt(0)
    v_cmp_ne_u32 vcc, s80, v15
    s_and_b32 s74, vcc_lo, 0xff0000
    s_cbranch_scc1 L_noe
    s_add_u32 s72, s12, 0
    buffer_load_dwordx4 v[164:167], v226, s[36:39], s72 offen offset:0 sc1
    buffer_load_dwordx4 v[168:171], v226, s[36:39], s72 offen offset:1024 sc1
    s_add_u32 s72, s12, 8192
    buffer_load_dwordx4 v[172:175], v226, s[36:39], s72 offen offset:0 sc1
    buffer_load_dwordx4 v[176:179], v226, s[36:39], s72 offen offset:1024 sc1
    s_add_u32 s72, s12, 16384
    buffer_load_dwordx4 v[180:183], v226, s[36:39], s72 offen offset:0 sc1
    buffer_load_dwordx4 v[184:187], v226, s[36:39], s72 offen offset:1024 sc1
    s_add_u32 s72, s12, 24576
    buffer_load_dwordx4 v[188:191], v226, s[36:39], s72 offen offset:0 sc1
    buffer_load_dwordx4 v[192:195], v226, s[36:39], s72 offen offset:1024 sc1
L_noe:
    ds_write_b128 v231, v[24:27] offset:0
    ds_write_b128 v231, v[28:31] offset:1024
    ds_write_b128 v232, v[32:35] offset:0
    ds_write_b128 v232, v[36:39] offset:1024
    ds_write_b128 v233, v[40:43] offset:0
    ds_write_b128 v233, v[44:47] offset:1024
    s_waitcnt lgkmcnt(0)
    s_cmp_lg_u32 s64, 0
    s_cbranch_scc1 PL_32d
    s_mov_b64 exec, 16711680
    s_mov_b32 s73, 0
    s_mov_b32 s72, 4096
    v_cmp_ne_u32 vcc, s80, v15
    s_cbranch_vccz PL_32x
PL_32:
    buffer_load_dword v15, v197, s[36:39], s72 offen sc1
    s_waitcnt vmcnt(0)
    v_cmp_ne_u32 vcc, s80, v15
    s_add_u32 s73, s73, 1
    s_cmp_gt_u32 s73, 20000
    s_cbranch_scc1 PL_32x
    s_cbranch_vccnz PL_32
PL_32x:
    s_mov_b64 exec, -1
PL_32d:
    s_barrier
    s_cmp_eq_u32 s74, 0
    s_cbranch_scc1 L_old
    s_add_u32 s72, s12, 0
    buffer_load_dwordx4 v[164:167], v226, s[36:39], s72 offen offset:0 sc1
    buffer_load_dwordx4 v[168:171], v226, s[36:39], s72 offen offset:1024 sc1
    s_add_u32 s72, s12, 8192
    buffer_load_dwordx4 v[172:175], v226, s[36:39], s72 offen offset:0 sc1
    buffer_load_dwordx4 v[176:179], v226, s[36:39], s72 offen offset:1024 sc1
    s_add_u32 s72, s12, 16384
    buffer_load_dwordx4 v[180:183], v226, s[36:39], s72 offen offset:0 sc1
    buffer_load_dwordx4 v[184:187], v226, s[36:39], s72 offen offset:1024 sc1
    s_add_u32 s72, s12, 24576
    buffer_load_dwordx4 v[188:191], v226, s[36:39], s72 offen offset:0 sc1
    buffer_load_dwordx4 v[192:195], v226, s[36:39], s72 offen offset:1024 sc1
L_old:
    ds_read_b128 v[96:99], v234 offset:0
    ds_read_b128 v[100:103], v234 offset:1024
    ds_read_b128 v[104:107], v234 offset:2048
    ds_read_b128 v[108:111], v234 offset:3072
    ds_read_b128 v[112:115], v234 offset:4096
    ds_read_b128 v[116:119], v234 offset:5120
    s_waitcnt lgkmcnt(4)
    v_pk_add_f32 v[16:17], v[16:17], v[96:97]
    v_pk_add_f32 v[18:19], v[18:19], v[98:99]
    v_pk_add_f32 v[20:21], v[20:21], v[100:101]
    v_pk_add_f32 v[22:23], v[22:23], v[102:103]
    s_waitcnt lgkmcnt(2)
    v_pk_add_f32 v[16:17], v[16:17], v[104:105]
    v_pk_add_f32 v[18:19], v[18:19], v[106:107]
    v_pk_add_f32 v[20:21], v[20:21], v[108:109]
    v_pk_add_f32 v[22:23], v[22:23], v[110:111]
    s_waitcnt lgkmcnt(0)
    v_pk_add_f32 v[48:49], v[16:17], v[112:113]
    v_pk_add_f32 v[50:51], v[18:19], v[114:115]
    v_pk_add_f32 v[52:53], v[20:21], v[116:117]
    v_pk_add_f32 v[54:55], v[22:23], v[118:119]
    ds_read_b64_tr_b16 v[64:65], v229 offset:16384
    ds_read_b64_tr_b16 v[66:67], v229 offset:16896
    ds_read_b64_tr_b16 v[68:69], v230 offset:16384
    ds_read_b64_tr_b16 v[70:71], v230 offset:16896
    ds_read_b64_tr_b16 v[72:73], v229 offset:17408
    ds_read_b64_tr_b16 v[74:75], v229 offset:17920
    ds_read_b64_tr_b16 v[76:77], v230 offset:17408
    ds_read_b64_tr_b16 v[78:79], v230 offset:17920
    v_mul_f32 v96, 0xbfb8aa3b, v48
    v_mul_f32 v97, 0xbfb8aa3b, v49
    v_mul_f32 v98, 0xbfb8aa3b, v50
    v_mul_f32 v99, 0xbfb8aa3b, v51
    v_mul_f32 v100, 0xbfb8aa3b, v52
    v_mul_f32 v101, 0xbfb8aa3b, v53
    v_mul_f32 v102, 0xbfb8aa3b, v54
    v_mul_f32 v103, 0xbfb8aa3b, v55
    v_exp_f32 v96, v96
    v_exp_f32 v97, v97
    v_exp_f32 v98, v98
    v_exp_f32 v99, v99
    v_exp_f32 v100, v100
    v_exp_f32 v101, v101
    v_exp_f32 v102, v102
    v_exp_f32 v103, v103
    v_pk_add_f32 v[96:97], v[96:97], 1.0 op_sel_hi:[1,0]
    v_pk_add_f32 v[98:99], v[98:99], 1.0 op_sel_hi:[1,0]
    v_pk_add_f32 v[100:101], v[100:101], 1.0 op_sel_hi:[1,0]
    v_pk_add_f32 v[102:103], v[102:103], 1.0 op_sel_hi:[1,0]
    v_rcp_f32 v96, v96
    v_rcp_f32 v97, v97
    v_rcp_f32 v98, v98
    v_rcp_f32 v99, v99
    v_rcp_f32 v100, v100
    v_rcp_f32 v101, v101
    v_rcp_f32 v102, v102
    v_rcp_f32 v103, v103
    v_pk_mul_f32 v[48:49], v[48:49], v[96:97]
    v_pk_mul_f32 v[50:51], v[50:51], v[98:99]
    v_pk_mul_f32 v[52:53], v[52:53], v[100:101]
    v_pk_mul_f32 v[54:55], v[54:55], v[102:103]
    s_waitcnt vmcnt(6) lgkmcnt(0)
    s_barrier
    v_mfma_f32_32x32x16_bf16 v[80:95], v[64:67], v[164:167], 0
    ds_read_b64_tr_b16 v[128:129], v229 offset:32768
    ds_read_b64_tr_b16 v[130:131], v229 offset:33280
    v_mfma_f32_32x32x16_bf16 v[148:163], v[68:71], v[164:167], 0
    ds_read_b64_tr_b16 v[132:133], v230 offset:32768
    ds_read_b64_tr_b16 v[134:135], v230 offset:33280
    v_mfma_f32_32x32x16_bf16 v[80:95], v[72:75], v[168:171], v[80:95]
    ds_read_b64_tr_b16 v[136:137], v229 offset:33792
    ds_read_b64_tr_b16 v[138:139], v229 offset:34304
    v_mfma_f32_32x32x16_bf16 v[148:163], v[76:79], v[168:171], v[148:163]
    ds_read_b64_tr_b16 v[200:201], v230 offset:33792
    ds_read_b64_tr_b16 v[202:203], v230 offset:34304
    s_waitcnt vmcnt(4) lgkmcnt(0)
    v_mfma_f32_32x32x16_bf16 v[80:95], v[128:131], v[172:175], v[80:95]
    ds_read_b64_tr_b16 v[64:65], v229 offset:49152
    ds_read_b64_tr_b16 v[66:67], v229 offset:49664
    v_mfma_f32_32x32x16_bf16 v[148:163], v[132:135], v[172:175], v[148:163]
    ds_read_b64_tr_b16 v[68:69], v230 offset:49152
    ds_read_b64_tr_b16 v[70:71], v230 offset:49664
    v_mfma_f32_32x32x16_bf16 v[80:95], v[136:139], v[176:179], v[80:95]
    ds_read_b64_tr_b16 v[72:73], v229 offset:50176
    ds_read_b64_tr_b16 v[74:75], v229 offset:50688
    v_mfma_f32_32x32x16_bf16 v[148:163], v[200:203], v[176:179], v[148:163]
    ds_read_b64_tr_b16 v[76:77], v230 offset:50176
    ds_read_b64_tr_b16 v[78:79], v230 offset:50688
    s_waitcnt vmcnt(2) lgkmcnt(0)
    v_mfma_f32_32x32x16_bf16 v[80:95], v[64:67], v[180:183], v[80:95]
    v_add_u32 v12, 131072, v229
    v_add_u32 v13, 131072, v230
    ds_read_b64_tr_b16 v[128:129], v12 offset:0
    ds_read_b64_tr_b16 v[130:131], v12 offset:512
    v_mfma_f32_32x32x16_bf16 v[148:163], v[68:71], v[180:183], v[148:163]
    ds_read_b64_tr_b16 v[132:133], v13 offset:0
    ds_read_b64_tr_b16 v[134:135], v13 offset:512
    v_mfma_f32_32x32x16_bf16 v[80:95], v[72:75], v[184:187], v[80:95]
    ds_read_b64_tr_b16 v[136:137], v12 offset:1024
    ds_read_b64_tr_b16 v[138:139], v12 offset:1536
    v_mfma_f32_32x32x16_bf16 v[148:163], v[76:79], v[184:187], v[148:163]
    ds_read_b64_tr_b16 v[200:201], v13 offset:1024
    ds_read_b64_tr_b16 v[202:203], v13 offset:1536
    s_waitcnt vmcnt(0) lgkmcnt(0)
    v_mfma_f32_32x32x16_bf16 v[80:95], v[128:131], v[188:191], v[80:95]
    v_mfma_f32_32x32x16_bf16 v[148:163], v[132:135], v[188:191], v[148:163]
    v_mfma_f32_32x32x16_bf16 v[80:95], v[136:139], v[192:195], v[80:95]
    v_mfma_f32_32x32x16_bf16 v[148:163], v[200:203], v[192:195], v[148:163]
    s_nop 7
    s_nop 2
    ds_write_b128 v231, v[88:91] offset:0
    ds_write_b128 v231, v[92:95] offset:1024
    ds_write_b128 v232, v[148:151] offset:0
    ds_write_b128 v232, v[152:155] offset:1024
    ds_write_b128 v233, v[156:159] offset:0
    ds_write_b128 v233, v[160:163] offset:1024
    s_waitcnt lgkmcnt(0)
    s_barrier
    ds_read_b128 v[96:99], v234 offset:0
    ds_read_b128 v[100:103], v234 offset:1024
    ds_read_b128 v[104:107], v234 offset:2048
    ds_read_b128 v[108:111], v234 offset:3072
    ds_read_b128 v[112:115], v234 offset:4096
    ds_read_b128 v[116:119], v234 offset:5120
    s_waitcnt lgkmcnt(4)
    v_pk_add_f32 v[80:81], v[80:81], v[96:97]
    v_pk_add_f32 v[82:83], v[82:83], v[98:99]
    v_pk_add_f32 v[84:85], v[84:85], v[100:101]
    v_pk_add_f32 v[86:87], v[86:87], v[102:103]
    s_waitcnt lgkmcnt(2)
    v_pk_add_f32 v[80:81], v[80:81], v[104:105]
    v_pk_add_f32 v[82:83], v[82:83], v[106:107]
    v_pk_add_f32 v[84:85], v[84:85], v[108:109]
    v_pk_add_f32 v[86:87], v[86:87], v[110:111]
    s_waitcnt lgkmcnt(0)
    v_pk_add_f32 v[80:81], v[80:81], v[112:113]
    v_pk_add_f32 v[82:83], v[82:83], v[114:115]
    v_pk_add_f32 v[84:85], v[84:85], v[116:117]
    v_pk_add_f32 v[86:87], v[86:87], v[118:119]
    v_pk_fma_f32 v[236:237], v[80:81], v[48:49], v[236:237]
    v_pk_fma_f32 v[238:239], v[82:83], v[50:51], v[238:239]
    v_pk_fma_f32 v[240:241], v[84:85], v[52:53], v[240:241]
    v_pk_fma_f32 v[242:243], v[86:87], v[54:55], v[242:243]
    v_cvt_pk_bf16_f32 v96, v236, v237
    v_cvt_pk_bf16_f32 v97, v238, v239
    v_cvt_pk_bf16_f32 v98, v240, v241
    v_cvt_pk_bf16_f32 v99, v242, v243
    s_nop 0
    v_permlane32_swap_b32 v96, v98
    v_permlane32_swap_b32 v97, v99
    buffer_store_dwordx4 v[96:99], v235, s[52:55], 0 offen
L_end:
    s_endpgm
.section .rodata,"a"
.p2align 6
.amdhsa_kernel recurrent_scan__linear_kernel_hedgehog__mixer_channel_mlp__prompt_kernel
  .amdhsa_next_free_vgpr 256
  .amdhsa_next_free_sgpr 102
  .amdhsa_accum_offset 256
  .amdhsa_group_segment_fixed_size 0
  .amdhsa_kernarg_size 96
  .amdhsa_user_sgpr_count 2
  .amdhsa_user_sgpr_kernarg_segment_ptr 1
  .amdhsa_system_sgpr_workgroup_id_x 1
.end_amdhsa_kernel
```
